```python
import torch

def _softmax(x, axis=-1):
    return torch.softmax(x, dim=axis)
def _gelu(x):
    return torch.nn.functional.gelu(x, approximate="tanh")
def _silu(x):
    return torch.nn.functional.silu(x)
def _sigmoid(x):
    return torch.sigmoid(x)
def _layernorm(x, axis=-1, eps=1e-5):
    m = x.mean(dim=axis, keepdim=True)
    v = x.var(dim=axis, keepdim=True, unbiased=False)
    return (x - m) / torch.sqrt(v + eps)
def _scatter_add(tgt, idx, src, axis=0):
    return tgt.clone().index_add_(axis, idx, src)
def _segment_sum(src, seg, n):
    out = torch.zeros((n,) + src.shape[1:], dtype=src.dtype)
    return out.index_add_(0, seg, src)
def _pad(x, pw):
    flat = tuple(v for pair in reversed(pw) for v in pair)
    return torch.nn.functional.pad(x, flat)

kernel_name = 'recurrent_scan__spectral_gfnet__swiglu_ffn__prompt'

def setup_inputs():

    _w = (lambda a: (lambda t: t.to(torch.bfloat16) if t.is_floating_point() else t)(torch.as_tensor(a)))
    def _A_setup():
        B, S, D = 1, 2048, 512
        Df = D // 2 + 1
        return {
            "x": _w((lambda *s: torch.randn(*s, dtype=torch.bfloat16) * 0.05)(B, S, D)),
            "w_r": _w((lambda *s: torch.randn(*s, dtype=torch.bfloat16) * 0.1)(S, Df) * 0.02),
            "w_i": _w((lambda *s: torch.randn(*s, dtype=torch.bfloat16) * 0.1)(S, Df) * 0.02),
        }
    _A_in = _A_setup()

    def _B_setup():
        B, S, D, F = 1, 2048, 512, 1792
        return {
            "x": _w((lambda *s: torch.randn(*s, dtype=torch.bfloat16) * 0.05)(B, S, D)),
            "w_gate": _w((lambda *s: torch.randn(*s, dtype=torch.bfloat16) * 0.05)(D, F)),
            "w_up": _w((lambda *s: torch.randn(*s, dtype=torch.bfloat16) * 0.05)(D, F)),
            "w_down": _w((lambda *s: torch.randn(*s, dtype=torch.bfloat16) * 0.05)(F, D)),
        }
    _B_in = _B_setup()

    return {
        "A_x": _A_in["x"],
        "A_w_r": _A_in["w_r"],
        "A_w_i": _A_in["w_i"],
        "B_x": _B_in["x"],
        "B_w_gate": _B_in["w_gate"],
        "B_w_up": _B_in["w_up"],
        "B_w_down": _B_in["w_down"],
    }

def reference(A_x, A_w_r, A_w_i, B_x, B_w_gate, B_w_up, B_w_down):
    def _A_ref(x, w_r, w_i):
        B, S, D = x.shape
        X = (lambda x, axes=(-2,-1): torch.fft.rfft2(x.float(), dim=axes))(x, axes=(-2, -1))
        W = w_r + 1j * w_i
        X = X * W
        y = (lambda x, s, axes=(-2,-1): torch.fft.irfft2(x, s=s, dim=axes).to(torch.bfloat16))(X, (S, D), axes=(-2, -1))
        return y

    def _B_ref(x, w_gate, w_up, w_down):
        g = _silu(x @ w_gate)
        u = x @ w_up
        return (g * u) @ w_down

    x = A_x
    xn = _layernorm(x, axis=-1)
    s = _A_ref(xn, A_w_r, A_w_i)
    g = _silu(_B_ref(xn, B_w_gate, B_w_up, B_w_down))
    return x + s * g
```

```asm
; @launch kernel=l1_kernel grid=(504,1,1) block=(256,1,1) lds=18432
; @launch kernel=l2_kernel grid=(481,1,1) block=(256,1,1) lds=65536
; @launch kernel=l3_kernel grid=(512,1,1) block=(256,1,1) lds=65536
.amdgcn_target "amdgcn-amd-amdhsa--gfx950"
.text
.globl l1_kernel
.p2align 8
.type l1_kernel,@function
l1_kernel:
    s_load_dwordx2 s[4:5], s[0:1], 0
    s_load_dwordx2 s[6:7], s[0:1], 72
    s_cmp_ge_u32 s2, 504
    s_cbranch_scc1 l1_end
    s_waitcnt lgkmcnt(0)
    s_cmp_lt_u32 s2, 256
    s_cbranch_scc1 l1_ka_start
    s_cmp_lt_u32 s2, 424
    s_cbranch_scc1 l1_kp_start
    s_branch l1_kw_start
l1_ka_start:
    s_and_b32 s3, s2, 7
    s_lshl_b32 s3, s3, 5
    s_lshr_b32 s45, s2, 3
    s_add_u32 s3, s3, s45
    v_and_b32 v1, 63, v0
    v_lshrrev_b32 v2, 6, v0
    s_nop 0
    v_readfirstlane_b32 s8, v2
    s_waitcnt lgkmcnt(0)
    s_lshl_b32 s9, s3, 2
    s_add_u32 s9, s9, s8
    s_mul_i32 s10, s8, 4608
    s_mov_b32 s12, s4
    s_mov_b32 s13, s5
    s_mov_b32 s14, 0x200000
    s_mov_b32 s15, 0x00020000
    s_mov_b32 s16, s6
    s_mov_b32 s17, s7
    s_mov_b32 s18, 0x200000
    s_mov_b32 s19, 0x00020000
    s_add_u32 s20, s6, 0x800000
    s_addc_u32 s21, s7, 0
    s_mov_b32 s22, 0x404000
    s_mov_b32 s23, 0x00020000
    s_lshl_b32 s11, s9, 11
    v_lshlrev_b32 v3, 4, v1
    buffer_load_dwordx4 v[4:7], v3, s[12:15], s11 offen
    buffer_load_dwordx4 v[8:11], v3, s[12:15], s11 offen offset:1024
    s_mov_b32 s26, 0x3f3504f3
    v_and_b32 v12, 511, v1
    v_cvt_f32_u32 v12, v12
    v_mul_f32 v12, 0xbb000000, v12
    v_cos_f32 v52, v12
    v_sin_f32 v53, v12
    v_mul_u32_u24 v12, 2, v1
    v_and_b32 v12, 511, v12
    v_cvt_f32_u32 v12, v12
    v_mul_f32 v12, 0xbb000000, v12
    v_cos_f32 v54, v12
    v_sin_f32 v55, v12
    v_mul_u32_u24 v12, 3, v1
    v_and_b32 v12, 511, v12
    v_cvt_f32_u32 v12, v12
    v_mul_f32 v12, 0xbb000000, v12
    v_cos_f32 v56, v12
    v_sin_f32 v57, v12
    v_mul_u32_u24 v12, 4, v1
    v_and_b32 v12, 511, v12
    v_cvt_f32_u32 v12, v12
    v_mul_f32 v12, 0xbb000000, v12
    v_cos_f32 v58, v12
    v_sin_f32 v59, v12
    v_mul_u32_u24 v12, 5, v1
    v_and_b32 v12, 511, v12
    v_cvt_f32_u32 v12, v12
    v_mul_f32 v12, 0xbb000000, v12
    v_cos_f32 v60, v12
    v_sin_f32 v61, v12
    v_mul_u32_u24 v12, 6, v1
    v_and_b32 v12, 511, v12
    v_cvt_f32_u32 v12, v12
    v_mul_f32 v12, 0xbb000000, v12
    v_cos_f32 v62, v12
    v_sin_f32 v63, v12
    v_mul_u32_u24 v12, 7, v1
    v_and_b32 v12, 511, v12
    v_cvt_f32_u32 v12, v12
    v_mul_f32 v12, 0xbb000000, v12
    v_cos_f32 v64, v12
    v_sin_f32 v65, v12
    s_nop 0
    v_and_b32 v13, 7, v1
    v_and_b32 v12, 63, v13
    v_cvt_f32_u32 v12, v12
    v_mul_f32 v12, 0xbc800000, v12
    v_cos_f32 v66, v12
    v_sin_f32 v67, v12
    v_mul_u32_u24 v12, 2, v13
    v_and_b32 v12, 63, v12
    v_cvt_f32_u32 v12, v12
    v_mul_f32 v12, 0xbc800000, v12
    v_cos_f32 v68, v12
    v_sin_f32 v69, v12
    v_mul_u32_u24 v12, 3, v13
    v_and_b32 v12, 63, v12
    v_cvt_f32_u32 v12, v12
    v_mul_f32 v12, 0xbc800000, v12
    v_cos_f32 v70, v12
    v_sin_f32 v71, v12
    v_mul_u32_u24 v12, 4, v13
    v_and_b32 v12, 63, v12
    v_cvt_f32_u32 v12, v12
    v_mul_f32 v12, 0xbc800000, v12
    v_cos_f32 v72, v12
    v_sin_f32 v73, v12
    v_mul_u32_u24 v12, 5, v13
    v_and_b32 v12, 63, v12
    v_cvt_f32_u32 v12, v12
    v_mul_f32 v12, 0xbc800000, v12
    v_cos_f32 v74, v12
    v_sin_f32 v75, v12
    v_mul_u32_u24 v12, 6, v13
    v_and_b32 v12, 63, v12
    v_cvt_f32_u32 v12, v12
    v_mul_f32 v12, 0xbc800000, v12
    v_cos_f32 v76, v12
    v_sin_f32 v77, v12
    v_mul_u32_u24 v12, 7, v13
    v_and_b32 v12, 63, v12
    v_cvt_f32_u32 v12, v12
    v_mul_f32 v12, 0xbc800000, v12
    v_cos_f32 v78, v12
    v_sin_f32 v79, v12
    s_nop 0
    v_mul_u32_u24 v14, 72, v1
    v_add_u32 v14, s10, v14
    v_lshrrev_b32 v12, 3, v1
    v_add_u32 v15, v12, v1
    v_lshlrev_b32 v15, 3, v15
    v_add_u32 v15, s10, v15
    v_lshlrev_b32 v80, 3, v1
    v_add_u32 v80, s10, v80
    v_mul_u32_u24 v81, 576, v12
    v_add_u32 v81, s10, v81
    v_lshlrev_b32 v82, 3, v13
    v_add_u32 v82, v81, v82
    v_lshlrev_b32 v83, 6, v13
    v_add_u32 v83, v81, v83
    v_sub_u32 v84, 256, v1
    v_lshlrev_b32 v84, 3, v84
    v_add_u32 v84, s10, v84
    v_lshrrev_b32 v85, 1, v1
    v_lshlrev_b32 v85, 10, v85
    v_and_b32 v12, 1, v1
    v_lshlrev_b32 v12, 9, v12
    v_add_u32 v85, v85, v12
    v_lshlrev_b32 v86, 14, v1
    s_lshr_b32 s27, s9, 4
    s_lshl_b32 s27, s27, 15
    s_and_b32 s28, s9, 15
    s_lshl_b32 s28, s28, 5
    s_add_u32 s27, s27, s28
    s_lshl_b32 s29, s9, 4
    v_mov_b32 v87, 0x3b000000
    s_waitcnt vmcnt(0)
    v_lshlrev_b32 v16, 16, v4
    v_and_b32 v18, 0xffff0000, v4
    v_lshlrev_b32 v17, 16, v8
    v_and_b32 v19, 0xffff0000, v8
    v_lshlrev_b32 v20, 16, v5
    v_and_b32 v22, 0xffff0000, v5
    v_lshlrev_b32 v21, 16, v9
    v_and_b32 v23, 0xffff0000, v9
    v_lshlrev_b32 v24, 16, v6
    v_and_b32 v26, 0xffff0000, v6
    v_lshlrev_b32 v25, 16, v10
    v_and_b32 v27, 0xffff0000, v10
    v_lshlrev_b32 v28, 16, v7
    v_and_b32 v30, 0xffff0000, v7
    v_lshlrev_b32 v29, 16, v11
    v_and_b32 v31, 0xffff0000, v11
    v_add_f32 v88, v16, v18
    v_add_f32 v89, v17, v19
    v_add_f32 v88, v88, v20
    v_add_f32 v89, v89, v21
    v_add_f32 v88, v88, v22
    v_add_f32 v89, v89, v23
    v_add_f32 v88, v88, v24
    v_add_f32 v89, v89, v25
    v_add_f32 v88, v88, v26
    v_add_f32 v89, v89, v27
    v_add_f32 v88, v88, v28
    v_add_f32 v89, v89, v29
    v_add_f32 v88, v88, v30
    v_add_f32 v89, v89, v31
    s_nop 1
    v_add_f32_dpp v88, v88, v88 row_shr:1 row_mask:0xf bank_mask:0xf bound_ctrl:0
    v_add_f32_dpp v89, v89, v89 row_shr:1 row_mask:0xf bank_mask:0xf bound_ctrl:0
    s_nop 1
    v_add_f32_dpp v88, v88, v88 row_shr:2 row_mask:0xf bank_mask:0xf bound_ctrl:0
    v_add_f32_dpp v89, v89, v89 row_shr:2 row_mask:0xf bank_mask:0xf bound_ctrl:0
    s_nop 1
    v_add_f32_dpp v88, v88, v88 row_shr:4 row_mask:0xf bank_mask:0xf bound_ctrl:0
    v_add_f32_dpp v89, v89, v89 row_shr:4 row_mask:0xf bank_mask:0xf bound_ctrl:0
    s_nop 1
    v_add_f32_dpp v88, v88, v88 row_shr:8 row_mask:0xf bank_mask:0xf bound_ctrl:0
    v_add_f32_dpp v89, v89, v89 row_shr:8 row_mask:0xf bank_mask:0xf bound_ctrl:0
    s_nop 1
    v_add_f32_dpp v88, v88, v88 row_bcast:15 row_mask:0xa bank_mask:0xf
    v_add_f32_dpp v89, v89, v89 row_bcast:15 row_mask:0xa bank_mask:0xf
    s_nop 1
    v_add_f32_dpp v88, v88, v88 row_bcast:31 row_mask:0xc bank_mask:0xf
    v_add_f32_dpp v89, v89, v89 row_bcast:31 row_mask:0xc bank_mask:0xf
    s_nop 1
    v_readlane_b32 s30, v88, 63
    v_readlane_b32 s31, v89, 63
    s_nop 1
    v_mul_f32 v90, s30, v87
    v_mul_f32 v91, s31, v87
    v_sub_f32 v12, v16, v90
    v_sub_f32 v13, v17, v91
    v_mul_f32 v88, v12, v12
    v_mul_f32 v89, v13, v13
    v_sub_f32 v12, v18, v90
    v_sub_f32 v13, v19, v91
    v_fmac_f32 v88, v12, v12
    v_fmac_f32 v89, v13, v13
    v_sub_f32 v12, v20, v90
    v_sub_f32 v13, v21, v91
    v_fmac_f32 v88, v12, v12
    v_fmac_f32 v89, v13, v13
    v_sub_f32 v12, v22, v90
    v_sub_f32 v13, v23, v91
    v_fmac_f32 v88, v12, v12
    v_fmac_f32 v89, v13, v13
    v_sub_f32 v12, v24, v90
    v_sub_f32 v13, v25, v91
    v_fmac_f32 v88, v12, v12
    v_fmac_f32 v89, v13, v13
    v_sub_f32 v12, v26, v90
    v_sub_f32 v13, v27, v91
    v_fmac_f32 v88, v12, v12
    v_fmac_f32 v89, v13, v13
    v_sub_f32 v12, v28, v90
    v_sub_f32 v13, v29, v91
    v_fmac_f32 v88, v12, v12
    v_fmac_f32 v89, v13, v13
    v_sub_f32 v12, v30, v90
    v_sub_f32 v13, v31, v91
    v_fmac_f32 v88, v12, v12
    v_fmac_f32 v89, v13, v13
    s_nop 1
    v_add_f32_dpp v88, v88, v88 row_shr:1 row_mask:0xf bank_mask:0xf bound_ctrl:0
    v_add_f32_dpp v89, v89, v89 row_shr:1 row_mask:0xf bank_mask:0xf bound_ctrl:0
    s_nop 1
    v_add_f32_dpp v88, v88, v88 row_shr:2 row_mask:0xf bank_mask:0xf bound_ctrl:0
    v_add_f32_dpp v89, v89, v89 row_shr:2 row_mask:0xf bank_mask:0xf bound_ctrl:0
    s_nop 1
    v_add_f32_dpp v88, v88, v88 row_shr:4 row_mask:0xf bank_mask:0xf bound_ctrl:0
    v_add_f32_dpp v89, v89, v89 row_shr:4 row_mask:0xf bank_mask:0xf bound_ctrl:0
    s_nop 1
    v_add_f32_dpp v88, v88, v88 row_shr:8 row_mask:0xf bank_mask:0xf bound_ctrl:0
    v_add_f32_dpp v89, v89, v89 row_shr:8 row_mask:0xf bank_mask:0xf bound_ctrl:0
    s_nop 1
    v_add_f32_dpp v88, v88, v88 row_bcast:15 row_mask:0xa bank_mask:0xf
    v_add_f32_dpp v89, v89, v89 row_bcast:15 row_mask:0xa bank_mask:0xf
    s_nop 1
    v_add_f32_dpp v88, v88, v88 row_bcast:31 row_mask:0xc bank_mask:0xf
    v_add_f32_dpp v89, v89, v89 row_bcast:31 row_mask:0xc bank_mask:0xf
    s_nop 1
    v_readlane_b32 s30, v88, 63
    v_readlane_b32 s31, v89, 63
    s_nop 1
    v_mul_f32 v92, s30, v87
    v_mul_f32 v93, s31, v87
    v_cvt_pk_bf16_f32 v12, v90, v91
    v_lshlrev_b32 v90, 16, v12
    v_and_b32 v91, 0xffff0000, v12
    v_cvt_pk_bf16_f32 v12, v92, v93
    v_lshlrev_b32 v92, 16, v12
    v_and_b32 v93, 0xffff0000, v12
    v_add_f32 v92, 0x3727c5ac, v92
    v_add_f32 v93, 0x3727c5ac, v93
    v_cvt_pk_bf16_f32 v12, v92, v93
    v_lshlrev_b32 v92, 16, v12
    v_and_b32 v93, 0xffff0000, v12
    v_sqrt_f32 v92, v92
    v_sqrt_f32 v93, v93
    s_nop 0
    v_cvt_pk_bf16_f32 v12, v92, v93
    v_lshlrev_b32 v92, 16, v12
    v_and_b32 v93, 0xffff0000, v12
    v_rcp_f32 v94, v92
    v_rcp_f32 v95, v93
    s_nop 0
    v_fma_f32 v12, -v92, v94, 1.0
    v_fma_f32 v13, -v93, v95, 1.0
    v_fma_f32 v94, v94, v12, v94
    v_fma_f32 v95, v95, v13, v95
    v_sub_f32 v12, v16, v90
    v_sub_f32 v13, v18, v90
    v_cvt_pk_bf16_f32 v12, v12, v13
    v_and_b32 v13, 0xffff0000, v12
    v_lshlrev_b32 v12, 16, v12
    v_mul_f32 v12, v12, v94
    v_mul_f32 v13, v13, v94
    v_cvt_pk_bf16_f32 v96, v12, v13
    v_lshlrev_b32 v16, 16, v96
    v_and_b32 v18, 0xffff0000, v96
    v_sub_f32 v12, v20, v90
    v_sub_f32 v13, v22, v90
    v_cvt_pk_bf16_f32 v12, v12, v13
    v_and_b32 v13, 0xffff0000, v12
    v_lshlrev_b32 v12, 16, v12
    v_mul_f32 v12, v12, v94
    v_mul_f32 v13, v13, v94
    v_cvt_pk_bf16_f32 v97, v12, v13
    v_lshlrev_b32 v20, 16, v97
    v_and_b32 v22, 0xffff0000, v97
    v_sub_f32 v12, v24, v90
    v_sub_f32 v13, v26, v90
    v_cvt_pk_bf16_f32 v12, v12, v13
    v_and_b32 v13, 0xffff0000, v12
    v_lshlrev_b32 v12, 16, v12
    v_mul_f32 v12, v12, v94
    v_mul_f32 v13, v13, v94
    v_cvt_pk_bf16_f32 v98, v12, v13
    v_lshlrev_b32 v24, 16, v98
    v_and_b32 v26, 0xffff0000, v98
    v_sub_f32 v12, v28, v90
    v_sub_f32 v13, v30, v90
    v_cvt_pk_bf16_f32 v12, v12, v13
    v_and_b32 v13, 0xffff0000, v12
    v_lshlrev_b32 v12, 16, v12
    v_mul_f32 v12, v12, v94
    v_mul_f32 v13, v13, v94
    v_cvt_pk_bf16_f32 v99, v12, v13
    v_lshlrev_b32 v28, 16, v99
    v_and_b32 v30, 0xffff0000, v99
    v_sub_f32 v12, v17, v91
    v_sub_f32 v13, v19, v91
    v_cvt_pk_bf16_f32 v12, v12, v13
    v_and_b32 v13, 0xffff0000, v12
    v_lshlrev_b32 v12, 16, v12
    v_mul_f32 v12, v12, v95
    v_mul_f32 v13, v13, v95
    v_cvt_pk_bf16_f32 v100, v12, v13
    v_lshlrev_b32 v17, 16, v100
    v_and_b32 v19, 0xffff0000, v100
    v_sub_f32 v12, v21, v91
    v_sub_f32 v13, v23, v91
    v_cvt_pk_bf16_f32 v12, v12, v13
    v_and_b32 v13, 0xffff0000, v12
    v_lshlrev_b32 v12, 16, v12
    v_mul_f32 v12, v12, v95
    v_mul_f32 v13, v13, v95
    v_cvt_pk_bf16_f32 v101, v12, v13
    v_lshlrev_b32 v21, 16, v101
    v_and_b32 v23, 0xffff0000, v101
    v_sub_f32 v12, v25, v91
    v_sub_f32 v13, v27, v91
    v_cvt_pk_bf16_f32 v12, v12, v13
    v_and_b32 v13, 0xffff0000, v12
    v_lshlrev_b32 v12, 16, v12
    v_mul_f32 v12, v12, v95
    v_mul_f32 v13, v13, v95
    v_cvt_pk_bf16_f32 v102, v12, v13
    v_lshlrev_b32 v25, 16, v102
    v_and_b32 v27, 0xffff0000, v102
    v_sub_f32 v12, v29, v91
    v_sub_f32 v13, v31, v91
    v_cvt_pk_bf16_f32 v12, v12, v13
    v_and_b32 v13, 0xffff0000, v12
    v_lshlrev_b32 v12, 16, v12
    v_mul_f32 v12, v12, v95
    v_mul_f32 v13, v13, v95
    v_cvt_pk_bf16_f32 v103, v12, v13
    v_lshlrev_b32 v29, 16, v103
    v_and_b32 v31, 0xffff0000, v103
    buffer_store_dwordx4 v[96:99], v85, s[16:19], s27 offen
    buffer_store_dwordx4 v[100:103], v85, s[16:19], s27 offen offset:16
    ds_write_b64 v14, v[16:17] offset:0
    ds_write_b64 v14, v[18:19] offset:8
    ds_write_b64 v14, v[20:21] offset:16
    ds_write_b64 v14, v[22:23] offset:24
    ds_write_b64 v14, v[24:25] offset:32
    ds_write_b64 v14, v[26:27] offset:40
    ds_write_b64 v14, v[28:29] offset:48
    ds_write_b64 v14, v[30:31] offset:56
    ds_read_b64 v[104:105], v15 offset:0
    ds_read_b64 v[106:107], v15 offset:576
    ds_read_b64 v[108:109], v15 offset:1152
    ds_read_b64 v[110:111], v15 offset:1728
    ds_read_b64 v[112:113], v15 offset:2304
    ds_read_b64 v[114:115], v15 offset:2880
    ds_read_b64 v[116:117], v15 offset:3456
    ds_read_b64 v[118:119], v15 offset:4032
    s_waitcnt lgkmcnt(0)
    v_add_f32 v120, v104, v112
    v_add_f32 v121, v105, v113
    v_add_f32 v122, v104, -v112
    v_add_f32 v123, v105, -v113
    v_add_f32 v124, v106, v114
    v_add_f32 v125, v107, v115
    v_add_f32 v126, v106, -v114
    v_add_f32 v127, v107, -v115
    v_add_f32 v128, v108, v116
    v_add_f32 v129, v109, v117
    v_add_f32 v130, v108, -v116
    v_add_f32 v131, v109, -v117
    v_add_f32 v132, v110, v118
    v_add_f32 v133, v111, v119
    v_add_f32 v134, v110, -v118
    v_add_f32 v135, v111, -v119
    v_add_f32 v136, v126, v127
    v_add_f32 v137, v127, -v126
    v_mul_f32 v136, s26, v136
    v_mul_f32 v137, s26, v137
    v_add_f32 v138, -v134, v135
    v_add_f32 v139, -v135, -v134
    v_mul_f32 v138, s26, v138
    v_mul_f32 v139, s26, v139
    v_add_f32 v140, v120, v128
    v_add_f32 v141, v121, v129
    v_add_f32 v142, v120, -v128
    v_add_f32 v143, v121, -v129
    v_add_f32 v144, v124, v132
    v_add_f32 v145, v125, v133
    v_add_f32 v146, v124, -v132
    v_add_f32 v147, v125, -v133
    v_add_f32 v148, v140, v144
    v_add_f32 v149, v141, v145
    v_add_f32 v150, v140, -v144
    v_add_f32 v151, v141, -v145
    v_add_f32 v104, v142, v147
    v_add_f32 v105, v143, -v146
    v_add_f32 v112, v142, -v147
    v_add_f32 v113, v143, v146
    v_add_f32 v106, v122, v131
    v_add_f32 v107, v123, -v130
    v_add_f32 v114, v122, -v131
    v_add_f32 v115, v123, v130
    v_add_f32 v108, v136, v138
    v_add_f32 v109, v137, v139
    v_add_f32 v116, v136, -v138
    v_add_f32 v117, v137, -v139
    v_add_f32 v110, v106, v108
    v_add_f32 v111, v107, v109
    v_add_f32 v118, v106, -v108
    v_add_f32 v119, v107, -v109
    v_add_f32 v126, v114, v117
    v_add_f32 v127, v115, -v116
    v_add_f32 v134, v114, -v117
    v_add_f32 v135, v115, v116
    v_mul_f32 v120, v110, v52
    v_fma_f32 v120, -v111, v53, v120
    v_mul_f32 v121, v110, v53
    v_fma_f32 v121, v111, v52, v121
    v_mul_f32 v128, v104, v54
    v_fma_f32 v128, -v105, v55, v128
    v_mul_f32 v129, v104, v55
    v_fma_f32 v129, v105, v54, v129
    v_mul_f32 v124, v126, v56
    v_fma_f32 v124, -v127, v57, v124
    v_mul_f32 v125, v126, v57
    v_fma_f32 v125, v127, v56, v125
    v_mul_f32 v132, v150, v58
    v_fma_f32 v132, -v151, v59, v132
    v_mul_f32 v133, v150, v59
    v_fma_f32 v133, v151, v58, v133
    v_mul_f32 v140, v118, v60
    v_fma_f32 v140, -v119, v61, v140
    v_mul_f32 v141, v118, v61
    v_fma_f32 v141, v119, v60, v141
    v_mul_f32 v144, v112, v62
    v_fma_f32 v144, -v113, v63, v144
    v_mul_f32 v145, v112, v63
    v_fma_f32 v145, v113, v62, v145
    v_mul_f32 v142, v134, v64
    v_fma_f32 v142, -v135, v65, v142
    v_mul_f32 v143, v134, v65
    v_fma_f32 v143, v135, v64, v143
    ds_write_b64 v80, v[148:149] offset:0
    ds_write_b64 v80, v[120:121] offset:576
    ds_write_b64 v80, v[128:129] offset:1152
    ds_write_b64 v80, v[124:125] offset:1728
    ds_write_b64 v80, v[132:133] offset:2304
    ds_write_b64 v80, v[140:141] offset:2880
    ds_write_b64 v80, v[144:145] offset:3456
    ds_write_b64 v80, v[142:143] offset:4032
    ds_read_b64 v[146:147], v82 offset:0
    ds_read_b64 v[122:123], v82 offset:64
    ds_read_b64 v[130:131], v82 offset:128
    ds_read_b64 v[136:137], v82 offset:192
    ds_read_b64 v[138:139], v82 offset:256
    ds_read_b64 v[106:107], v82 offset:320
    ds_read_b64 v[108:109], v82 offset:384
    ds_read_b64 v[114:115], v82 offset:448
    s_waitcnt lgkmcnt(0)
    v_add_f32 v116, v146, v138
    v_add_f32 v117, v147, v139
    v_add_f32 v110, v146, -v138
    v_add_f32 v111, v147, -v139
    v_add_f32 v104, v122, v106
    v_add_f32 v105, v123, v107
    v_add_f32 v126, v122, -v106
    v_add_f32 v127, v123, -v107
    v_add_f32 v150, v130, v108
    v_add_f32 v151, v131, v109
    v_add_f32 v118, v130, -v108
    v_add_f32 v119, v131, -v109
    v_add_f32 v112, v136, v114
    v_add_f32 v113, v137, v115
    v_add_f32 v134, v136, -v114
    v_add_f32 v135, v137, -v115
    v_add_f32 v148, v126, v127
    v_add_f32 v149, v127, -v126
    v_mul_f32 v148, s26, v148
    v_mul_f32 v149, s26, v149
    v_add_f32 v120, -v134, v135
    v_add_f32 v121, -v135, -v134
    v_mul_f32 v120, s26, v120
    v_mul_f32 v121, s26, v121
    v_add_f32 v128, v116, v150
    v_add_f32 v129, v117, v151
    v_add_f32 v124, v116, -v150
    v_add_f32 v125, v117, -v151
    v_add_f32 v132, v104, v112
    v_add_f32 v133, v105, v113
    v_add_f32 v140, v104, -v112
    v_add_f32 v141, v105, -v113
    v_add_f32 v144, v128, v132
    v_add_f32 v145, v129, v133
    v_add_f32 v142, v128, -v132
    v_add_f32 v143, v129, -v133
    v_add_f32 v146, v124, v141
    v_add_f32 v147, v125, -v140
    v_add_f32 v138, v124, -v141
    v_add_f32 v139, v125, v140
    v_add_f32 v122, v110, v119
    v_add_f32 v123, v111, -v118
    v_add_f32 v106, v110, -v119
    v_add_f32 v107, v111, v118
    v_add_f32 v130, v148, v120
    v_add_f32 v131, v149, v121
    v_add_f32 v108, v148, -v120
    v_add_f32 v109, v149, -v121
    v_add_f32 v136, v122, v130
    v_add_f32 v137, v123, v131
    v_add_f32 v114, v122, -v130
    v_add_f32 v115, v123, -v131
    v_add_f32 v126, v106, v109
    v_add_f32 v127, v107, -v108
    v_add_f32 v134, v106, -v109
    v_add_f32 v135, v107, v108
    v_mul_f32 v116, v136, v66
    v_fma_f32 v116, -v137, v67, v116
    v_mul_f32 v117, v136, v67
    v_fma_f32 v117, v137, v66, v117
    v_mul_f32 v150, v146, v68
    v_fma_f32 v150, -v147, v69, v150
    v_mul_f32 v151, v146, v69
    v_fma_f32 v151, v147, v68, v151
    v_mul_f32 v104, v126, v70
    v_fma_f32 v104, -v127, v71, v104
    v_mul_f32 v105, v126, v71
    v_fma_f32 v105, v127, v70, v105
    v_mul_f32 v112, v142, v72
    v_fma_f32 v112, -v143, v73, v112
    v_mul_f32 v113, v142, v73
    v_fma_f32 v113, v143, v72, v113
    v_mul_f32 v128, v114, v74
    v_fma_f32 v128, -v115, v75, v128
    v_mul_f32 v129, v114, v75
    v_fma_f32 v129, v115, v74, v129
    v_mul_f32 v132, v138, v76
    v_fma_f32 v132, -v139, v77, v132
    v_mul_f32 v133, v138, v77
    v_fma_f32 v133, v139, v76, v133
    v_mul_f32 v124, v134, v78
    v_fma_f32 v124, -v135, v79, v124
    v_mul_f32 v125, v134, v79
    v_fma_f32 v125, v135, v78, v125
    ds_write_b64 v80, v[144:145] offset:0
    ds_write_b64 v80, v[116:117] offset:576
    ds_write_b64 v80, v[150:151] offset:1152
    ds_write_b64 v80, v[104:105] offset:1728
    ds_write_b64 v80, v[112:113] offset:2304
    ds_write_b64 v80, v[128:129] offset:2880
    ds_write_b64 v80, v[132:133] offset:3456
    ds_write_b64 v80, v[124:125] offset:4032
    ds_read_b64 v[140:141], v83 offset:0
    ds_read_b64 v[110:111], v83 offset:8
    ds_read_b64 v[118:119], v83 offset:16
    ds_read_b64 v[148:149], v83 offset:24
    ds_read_b64 v[120:121], v83 offset:32
    ds_read_b64 v[122:123], v83 offset:40
    ds_read_b64 v[130:131], v83 offset:48
    ds_read_b64 v[106:107], v83 offset:56
    s_waitcnt lgkmcnt(0)
    v_add_f32 v108, v140, v120
    v_add_f32 v109, v141, v121
    v_add_f32 v136, v140, -v120
    v_add_f32 v137, v141, -v121
    v_add_f32 v146, v110, v122
    v_add_f32 v147, v111, v123
    v_add_f32 v126, v110, -v122
    v_add_f32 v127, v111, -v123
    v_add_f32 v142, v118, v130
    v_add_f32 v143, v119, v131
    v_add_f32 v114, v118, -v130
    v_add_f32 v115, v119, -v131
    v_add_f32 v138, v148, v106
    v_add_f32 v139, v149, v107
    v_add_f32 v134, v148, -v106
    v_add_f32 v135, v149, -v107
    v_add_f32 v144, v126, v127
    v_add_f32 v145, v127, -v126
    v_mul_f32 v144, s26, v144
    v_mul_f32 v145, s26, v145
    v_add_f32 v116, -v134, v135
    v_add_f32 v117, -v135, -v134
    v_mul_f32 v116, s26, v116
    v_mul_f32 v117, s26, v117
    v_add_f32 v150, v108, v142
    v_add_f32 v151, v109, v143
    v_add_f32 v104, v108, -v142
    v_add_f32 v105, v109, -v143
    v_add_f32 v112, v146, v138
    v_add_f32 v113, v147, v139
    v_add_f32 v128, v146, -v138
    v_add_f32 v129, v147, -v139
    v_add_f32 v132, v150, v112
    v_add_f32 v133, v151, v113
    v_add_f32 v124, v150, -v112
    v_add_f32 v125, v151, -v113
    v_add_f32 v140, v104, v129
    v_add_f32 v141, v105, -v128
    v_add_f32 v120, v104, -v129
    v_add_f32 v121, v105, v128
    v_add_f32 v110, v136, v115
    v_add_f32 v111, v137, -v114
    v_add_f32 v122, v136, -v115
    v_add_f32 v123, v137, v114
    v_add_f32 v118, v144, v116
    v_add_f32 v119, v145, v117
    v_add_f32 v130, v144, -v116
    v_add_f32 v131, v145, -v117
    v_add_f32 v148, v110, v118
    v_add_f32 v149, v111, v119
    v_add_f32 v106, v110, -v118
    v_add_f32 v107, v111, -v119
    v_add_f32 v126, v122, v131
    v_add_f32 v127, v123, -v130
    v_add_f32 v134, v122, -v131
    v_add_f32 v135, v123, v130
    ds_write_b64 v80, v[132:133] offset:0
    ds_write_b64 v80, v[148:149] offset:512
    ds_write_b64 v80, v[140:141] offset:1024
    ds_write_b64 v80, v[126:127] offset:1536
    ds_write_b64 v80, v[124:125] offset:2048
    ds_write_b64 v80, v[106:107] offset:2560
    ds_write_b64 v80, v[120:121] offset:3072
    ds_write_b64 v80, v[134:135] offset:3584
    ds_write_b64 v80, v[132:133] offset:4096
    ds_read_b64 v[108:109], v84 offset:2048
    ds_read_b64 v[142:143], v84 offset:1536
    ds_read_b64 v[146:147], v84 offset:1024
    ds_read_b64 v[138:139], v84 offset:512
    ds_read_b64 v[150:151], v84 offset:0
    s_waitcnt lgkmcnt(0)
    v_add_f32 v152, v132, v108
    v_sub_f32 v153, v133, v109
    v_add_f32 v154, v133, v109
    v_sub_f32 v155, v108, v132
    v_add_f32 v156, v148, v142
    v_sub_f32 v157, v149, v143
    v_add_f32 v158, v149, v143
    v_sub_f32 v159, v142, v148
    v_add_f32 v160, v140, v146
    v_sub_f32 v161, v141, v147
    v_add_f32 v162, v141, v147
    v_sub_f32 v163, v146, v140
    v_add_f32 v164, v126, v138
    v_sub_f32 v165, v127, v139
    v_add_f32 v166, v127, v139
    v_sub_f32 v167, v138, v126
    v_add_f32 v168, v124, v150
    v_sub_f32 v169, v125, v151
    v_add_f32 v170, v125, v151
    v_sub_f32 v171, v150, v124
    s_add_u32 s32, s29, 0x0
    buffer_store_dwordx4 v[152:155], v86, s[20:23], s32 offen
    s_add_u32 s32, s29, 0x100000
    buffer_store_dwordx4 v[156:159], v86, s[20:23], s32 offen
    s_add_u32 s32, s29, 0x200000
    buffer_store_dwordx4 v[160:163], v86, s[20:23], s32 offen
    s_add_u32 s32, s29, 0x300000
    buffer_store_dwordx4 v[164:167], v86, s[20:23], s32 offen
    s_add_u32 s32, s29, 0x400000
    v_cmp_eq_u32 vcc, 0, v1
    s_and_saveexec_b64 s[34:35], vcc
    buffer_store_dwordx4 v[168:171], v86, s[20:23], s32 offen
    s_mov_b64 exec, s[34:35]
    s_endpgm
l1_kp_start:
    s_sub_u32 s2, s2, 256
    s_mov_b32 s3, s2
    s_load_dwordx4 s[36:39], s[0:1], 32
    s_load_dwordx2 s[40:41], s[0:1], 48
    v_and_b32 v1, 63, v0
    v_lshrrev_b32 v2, 6, v0
    s_nop 0
    v_readfirstlane_b32 s8, v2
    s_lshl_b32 s9, s3, 2
    s_add_u32 s9, s9, s8
    s_mul_i32 s9, s9, 4
    v_and_b32 v2, 31, v1
    v_lshrrev_b32 v3, 5, v1
    s_waitcnt lgkmcnt(0)
    s_cmp_ge_u32 s9, 1792
    s_cbranch_scc1 kp0_wd
    s_and_b32 s10, s9, 1
    s_lshr_b32 s11, s9, 1
    s_lshr_b32 s24, s11, 5
    s_and_b32 s25, s11, 31
    s_cmp_eq_u32 s10, 0
    s_cselect_b32 s12, s36, s38
    s_cselect_b32 s13, s37, s39
    s_mov_b32 s14, 1835008
    s_mov_b32 s15, 0x00020000
    s_mul_i32 s26, s25, 57344
    s_lshl_b32 s27, s24, 7
    s_add_u32 s26, s26, s27
    s_lshl_b32 s27, s24, 5
    s_add_u32 s27, s27, s25
    s_lshl_b32 s27, s27, 2
    s_lshl_b32 s28, s10, 1
    s_add_u32 s27, s27, s28
    s_lshl_b32 s27, s27, 10
    s_add_u32 s20, s6, 0x1800000
    s_addc_u32 s21, s7, 0
    s_mov_b32 s22, 0x380000
    s_mov_b32 s23, 0x00020000
    s_mov_b32 s29, 3584
    s_branch kp0_go
kp0_wd:
    s_sub_u32 s11, s9, 1792
    s_mul_hi_u32 s24, s11, 0x2492493
    s_mul_i32 s25, s24, 112
    s_sub_u32 s25, s11, s25
    s_mov_b32 s12, s40
    s_mov_b32 s13, s41
    s_mov_b32 s14, 1835008
    s_mov_b32 s15, 0x00020000
    s_lshl_b32 s26, s25, 14
    s_lshl_b32 s27, s24, 7
    s_add_u32 s26, s26, s27
    s_mul_i32 s27, s24, 112
    s_add_u32 s27, s27, s25
    s_lshl_b32 s27, s27, 11
    s_add_u32 s20, s6, 0x2000000
    s_addc_u32 s21, s7, 0
    s_mov_b32 s22, 0x1c0000
    s_mov_b32 s23, 0x00020000
    s_mov_b32 s29, 1024
kp0_go:
    s_lshl_b32 s30, s29, 3
    v_mul_lo_u32 v4, v3, s30
    v_lshlrev_b32 v5, 2, v2
    v_add_u32 v4, v4, v5
    s_mov_b32 s31, s26
    buffer_load_dword v8, v4, s[12:15], s31 offen
    s_add_u32 s31, s31, s29
    buffer_load_dword v9, v4, s[12:15], s31 offen
    s_add_u32 s31, s31, s29
    buffer_load_dword v10, v4, s[12:15], s31 offen
    s_add_u32 s31, s31, s29
    buffer_load_dword v11, v4, s[12:15], s31 offen
    s_add_u32 s31, s31, s29
    buffer_load_dword v12, v4, s[12:15], s31 offen
    s_add_u32 s31, s31, s29
    buffer_load_dword v13, v4, s[12:15], s31 offen
    s_add_u32 s31, s31, s29
    buffer_load_dword v14, v4, s[12:15], s31 offen
    s_add_u32 s31, s31, s29
    buffer_load_dword v15, v4, s[12:15], s31 offen
    s_mov_b32 s60, s27
    s_add_u32 s9, s9, 1
    s_cmp_ge_u32 s9, 1792
    s_cbranch_scc1 kp1_wd
    s_and_b32 s10, s9, 1
    s_lshr_b32 s11, s9, 1
    s_lshr_b32 s24, s11, 5
    s_and_b32 s25, s11, 31
    s_cmp_eq_u32 s10, 0
    s_cselect_b32 s12, s36, s38
    s_cselect_b32 s13, s37, s39
    s_mov_b32 s14, 1835008
    s_mov_b32 s15, 0x00020000
    s_mul_i32 s26, s25, 57344
    s_lshl_b32 s27, s24, 7
    s_add_u32 s26, s26, s27
    s_lshl_b32 s27, s24, 5
    s_add_u32 s27, s27, s25
    s_lshl_b32 s27, s27, 2
    s_lshl_b32 s28, s10, 1
    s_add_u32 s27, s27, s28
    s_lshl_b32 s27, s27, 10
    s_add_u32 s20, s6, 0x1800000
    s_addc_u32 s21, s7, 0
    s_mov_b32 s22, 0x380000
    s_mov_b32 s23, 0x00020000
    s_mov_b32 s29, 3584
    s_branch kp1_go
kp1_wd:
    s_sub_u32 s11, s9, 1792
    s_mul_hi_u32 s24, s11, 0x2492493
    s_mul_i32 s25, s24, 112
    s_sub_u32 s25, s11, s25
    s_mov_b32 s12, s40
    s_mov_b32 s13, s41
    s_mov_b32 s14, 1835008
    s_mov_b32 s15, 0x00020000
    s_lshl_b32 s26, s25, 14
    s_lshl_b32 s27, s24, 7
    s_add_u32 s26, s26, s27
    s_mul_i32 s27, s24, 112
    s_add_u32 s27, s27, s25
    s_lshl_b32 s27, s27, 11
    s_add_u32 s20, s6, 0x2000000
    s_addc_u32 s21, s7, 0
    s_mov_b32 s22, 0x1c0000
    s_mov_b32 s23, 0x00020000
    s_mov_b32 s29, 1024
kp1_go:
    s_lshl_b32 s30, s29, 3
    v_mul_lo_u32 v4, v3, s30
    v_lshlrev_b32 v5, 2, v2
    v_add_u32 v4, v4, v5
    s_mov_b32 s31, s26
    buffer_load_dword v16, v4, s[12:15], s31 offen
    s_add_u32 s31, s31, s29
    buffer_load_dword v17, v4, s[12:15], s31 offen
    s_add_u32 s31, s31, s29
    buffer_load_dword v18, v4, s[12:15], s31 offen
    s_add_u32 s31, s31, s29
    buffer_load_dword v19, v4, s[12:15], s31 offen
    s_add_u32 s31, s31, s29
    buffer_load_dword v20, v4, s[12:15], s31 offen
    s_add_u32 s31, s31, s29
    buffer_load_dword v21, v4, s[12:15], s31 offen
    s_add_u32 s31, s31, s29
    buffer_load_dword v22, v4, s[12:15], s31 offen
    s_add_u32 s31, s31, s29
    buffer_load_dword v23, v4, s[12:15], s31 offen
    s_mov_b32 s61, s27
    s_add_u32 s9, s9, 1
    s_cmp_ge_u32 s9, 1792
    s_cbranch_scc1 kp2_wd
    s_and_b32 s10, s9, 1
    s_lshr_b32 s11, s9, 1
    s_lshr_b32 s24, s11, 5
    s_and_b32 s25, s11, 31
    s_cmp_eq_u32 s10, 0
    s_cselect_b32 s12, s36, s38
    s_cselect_b32 s13, s37, s39
    s_mov_b32 s14, 1835008
    s_mov_b32 s15, 0x00020000
    s_mul_i32 s26, s25, 57344
    s_lshl_b32 s27, s24, 7
    s_add_u32 s26, s26, s27
    s_lshl_b32 s27, s24, 5
    s_add_u32 s27, s27, s25
    s_lshl_b32 s27, s27, 2
    s_lshl_b32 s28, s10, 1
    s_add_u32 s27, s27, s28
    s_lshl_b32 s27, s27, 10
    s_add_u32 s20, s6, 0x1800000
    s_addc_u32 s21, s7, 0
    s_mov_b32 s22, 0x380000
    s_mov_b32 s23, 0x00020000
    s_mov_b32 s29, 3584
    s_branch kp2_go
kp2_wd:
    s_sub_u32 s11, s9, 1792
    s_mul_hi_u32 s24, s11, 0x2492493
    s_mul_i32 s25, s24, 112
    s_sub_u32 s25, s11, s25
    s_mov_b32 s12, s40
    s_mov_b32 s13, s41
    s_mov_b32 s14, 1835008
    s_mov_b32 s15, 0x00020000
    s_lshl_b32 s26, s25, 14
    s_lshl_b32 s27, s24, 7
    s_add_u32 s26, s26, s27
    s_mul_i32 s27, s24, 112
    s_add_u32 s27, s27, s25
    s_lshl_b32 s27, s27, 11
    s_add_u32 s20, s6, 0x2000000
    s_addc_u32 s21, s7, 0
    s_mov_b32 s22, 0x1c0000
    s_mov_b32 s23, 0x00020000
    s_mov_b32 s29, 1024
kp2_go:
    s_lshl_b32 s30, s29, 3
    v_mul_lo_u32 v4, v3, s30
    v_lshlrev_b32 v5, 2, v2
    v_add_u32 v4, v4, v5
    s_mov_b32 s31, s26
    buffer_load_dword v24, v4, s[12:15], s31 offen
    s_add_u32 s31, s31, s29
    buffer_load_dword v25, v4, s[12:15], s31 offen
    s_add_u32 s31, s31, s29
    buffer_load_dword v26, v4, s[12:15], s31 offen
    s_add_u32 s31, s31, s29
    buffer_load_dword v27, v4, s[12:15], s31 offen
    s_add_u32 s31, s31, s29
    buffer_load_dword v28, v4, s[12:15], s31 offen
    s_add_u32 s31, s31, s29
    buffer_load_dword v29, v4, s[12:15], s31 offen
    s_add_u32 s31, s31, s29
    buffer_load_dword v30, v4, s[12:15], s31 offen
    s_add_u32 s31, s31, s29
    buffer_load_dword v31, v4, s[12:15], s31 offen
    s_mov_b32 s62, s27
    s_add_u32 s9, s9, 1
    s_cmp_ge_u32 s9, 1792
    s_cbranch_scc1 kp3_wd
    s_and_b32 s10, s9, 1
    s_lshr_b32 s11, s9, 1
    s_lshr_b32 s24, s11, 5
    s_and_b32 s25, s11, 31
    s_cmp_eq_u32 s10, 0
    s_cselect_b32 s12, s36, s38
    s_cselect_b32 s13, s37, s39
    s_mov_b32 s14, 1835008
    s_mov_b32 s15, 0x00020000
    s_mul_i32 s26, s25, 57344
    s_lshl_b32 s27, s24, 7
    s_add_u32 s26, s26, s27
    s_lshl_b32 s27, s24, 5
    s_add_u32 s27, s27, s25
    s_lshl_b32 s27, s27, 2
    s_lshl_b32 s28, s10, 1
    s_add_u32 s27, s27, s28
    s_lshl_b32 s27, s27, 10
    s_add_u32 s20, s6, 0x1800000
    s_addc_u32 s21, s7, 0
    s_mov_b32 s22, 0x380000
    s_mov_b32 s23, 0x00020000
    s_mov_b32 s29, 3584
    s_branch kp3_go
kp3_wd:
    s_sub_u32 s11, s9, 1792
    s_mul_hi_u32 s24, s11, 0x2492493
    s_mul_i32 s25, s24, 112
    s_sub_u32 s25, s11, s25
    s_mov_b32 s12, s40
    s_mov_b32 s13, s41
    s_mov_b32 s14, 1835008
    s_mov_b32 s15, 0x00020000
    s_lshl_b32 s26, s25, 14
    s_lshl_b32 s27, s24, 7
    s_add_u32 s26, s26, s27
    s_mul_i32 s27, s24, 112
    s_add_u32 s27, s27, s25
    s_lshl_b32 s27, s27, 11
    s_add_u32 s20, s6, 0x2000000
    s_addc_u32 s21, s7, 0
    s_mov_b32 s22, 0x1c0000
    s_mov_b32 s23, 0x00020000
    s_mov_b32 s29, 1024
kp3_go:
    s_lshl_b32 s30, s29, 3
    v_mul_lo_u32 v4, v3, s30
    v_lshlrev_b32 v5, 2, v2
    v_add_u32 v4, v4, v5
    s_mov_b32 s31, s26
    buffer_load_dword v32, v4, s[12:15], s31 offen
    s_add_u32 s31, s31, s29
    buffer_load_dword v33, v4, s[12:15], s31 offen
    s_add_u32 s31, s31, s29
    buffer_load_dword v34, v4, s[12:15], s31 offen
    s_add_u32 s31, s31, s29
    buffer_load_dword v35, v4, s[12:15], s31 offen
    s_add_u32 s31, s31, s29
    buffer_load_dword v36, v4, s[12:15], s31 offen
    s_add_u32 s31, s31, s29
    buffer_load_dword v37, v4, s[12:15], s31 offen
    s_add_u32 s31, s31, s29
    buffer_load_dword v38, v4, s[12:15], s31 offen
    s_add_u32 s31, s31, s29
    buffer_load_dword v39, v4, s[12:15], s31 offen
    s_mov_b32 s63, s27
    s_add_u32 s9, s9, 1
    v_lshrrev_b32 v5, 4, v2
    v_lshlrev_b32 v5, 10, v5
    v_lshlrev_b32 v6, 9, v3
    v_add_u32 v5, v5, v6
    v_and_b32 v6, 15, v2
    v_lshlrev_b32 v6, 5, v6
    v_add_u32 v5, v5, v6
    s_mov_b32 s32, 0x05040100
    s_mov_b32 s33, 0x07060302
    s_waitcnt vmcnt(24)
    v_perm_b32 v40, v9, v8, s32
    v_perm_b32 v44, v9, v8, s33
    v_perm_b32 v41, v11, v10, s32
    v_perm_b32 v45, v11, v10, s33
    v_perm_b32 v42, v13, v12, s32
    v_perm_b32 v46, v13, v12, s33
    v_perm_b32 v43, v15, v14, s32
    v_perm_b32 v47, v15, v14, s33
    s_waitcnt vmcnt(16)
    v_perm_b32 v48, v17, v16, s32
    v_perm_b32 v52, v17, v16, s33
    v_perm_b32 v49, v19, v18, s32
    v_perm_b32 v53, v19, v18, s33
    v_perm_b32 v50, v21, v20, s32
    v_perm_b32 v54, v21, v20, s33
    v_perm_b32 v51, v23, v22, s32
    v_perm_b32 v55, v23, v22, s33
    s_waitcnt vmcnt(8)
    v_perm_b32 v56, v25, v24, s32
    v_perm_b32 v60, v25, v24, s33
    v_perm_b32 v57, v27, v26, s32
    v_perm_b32 v61, v27, v26, s33
    v_perm_b32 v58, v29, v28, s32
    v_perm_b32 v62, v29, v28, s33
    v_perm_b32 v59, v31, v30, s32
    v_perm_b32 v63, v31, v30, s33
    s_waitcnt vmcnt(0)
    v_perm_b32 v64, v33, v32, s32
    v_perm_b32 v68, v33, v32, s33
    v_perm_b32 v65, v35, v34, s32
    v_perm_b32 v69, v35, v34, s33
    v_perm_b32 v66, v37, v36, s32
    v_perm_b32 v70, v37, v36, s33
    v_perm_b32 v67, v39, v38, s32
    v_perm_b32 v71, v39, v38, s33
    buffer_store_dwordx4 v[40:43], v5, s[20:23], s60 offen
    buffer_store_dwordx4 v[44:47], v5, s[20:23], s60 offen offset:16
    buffer_store_dwordx4 v[48:51], v5, s[20:23], s61 offen
    buffer_store_dwordx4 v[52:55], v5, s[20:23], s61 offen offset:16
    buffer_store_dwordx4 v[56:59], v5, s[20:23], s62 offen
    buffer_store_dwordx4 v[60:63], v5, s[20:23], s62 offen offset:16
    buffer_store_dwordx4 v[64:67], v5, s[20:23], s63 offen
    buffer_store_dwordx4 v[68:71], v5, s[20:23], s63 offen offset:16
    s_endpgm
l1_kw_start:
    s_sub_u32 s2, s2, 424
    s_mov_b32 s3, s2
    s_load_dwordx4 s[36:39], s[0:1], 8
    v_and_b32 v1, 63, v0
    v_lshrrev_b32 v2, 6, v0
    s_nop 0
    v_readfirstlane_b32 s8, v2
    s_lshl_b32 s9, s3, 2
    s_add_u32 s9, s9, s8
    s_mul_i32 s9, s9, 4
    s_lshr_b32 s11, s9, 8
    s_lshl_b32 s11, s11, 6
    v_add_u32 v2, s11, v1
    s_waitcnt lgkmcnt(0)
    s_mov_b32 s12, s36
    s_mov_b32 s13, s37
    s_mov_b32 s14, 0x101000
    s_mov_b32 s15, 0x00020000
    s_mov_b32 s16, s38
    s_mov_b32 s17, s39
    s_mov_b32 s18, 0x101000
    s_mov_b32 s19, 0x00020000
    s_add_u32 s20, s6, 0x1000000
    s_addc_u32 s21, s7, 0
    s_mov_b32 s22, 0x202000
    s_mov_b32 s23, 0x00020000
    v_lshlrev_b32 v3, 1, v2
    s_and_b32 s10, s9, 255
    s_lshr_b32 s24, s10, 2
    s_and_b32 s25, s10, 3
    s_lshl_b32 s25, s25, 6
    s_add_u32 s24, s24, s25
    s_add_u32 s26, s24, 0
    s_mul_i32 s40, s26, 514
    buffer_load_ushort v8, v3, s[12:15], s40 offen
    buffer_load_ushort v16, v3, s[16:19], s40 offen
    s_add_u32 s26, s24, 512
    s_mul_i32 s41, s26, 514
    buffer_load_ushort v9, v3, s[12:15], s41 offen
    buffer_load_ushort v17, v3, s[16:19], s41 offen
    s_add_u32 s26, s24, 1024
    s_mul_i32 s42, s26, 514
    buffer_load_ushort v10, v3, s[12:15], s42 offen
    buffer_load_ushort v18, v3, s[16:19], s42 offen
    s_add_u32 s26, s24, 1536
    s_mul_i32 s43, s26, 514
    buffer_load_ushort v11, v3, s[12:15], s43 offen
    buffer_load_ushort v19, v3, s[16:19], s43 offen
    s_add_u32 s26, s24, 256
    s_mul_i32 s44, s26, 514
    buffer_load_ushort v12, v3, s[12:15], s44 offen
    buffer_load_ushort v20, v3, s[16:19], s44 offen
    s_add_u32 s26, s24, 768
    s_mul_i32 s45, s26, 514
    buffer_load_ushort v13, v3, s[12:15], s45 offen
    buffer_load_ushort v21, v3, s[16:19], s45 offen
    s_add_u32 s26, s24, 1280
    s_mul_i32 s46, s26, 514
    buffer_load_ushort v14, v3, s[12:15], s46 offen
    buffer_load_ushort v22, v3, s[16:19], s46 offen
    s_add_u32 s26, s24, 1792
    s_mul_i32 s47, s26, 514
    buffer_load_ushort v15, v3, s[12:15], s47 offen
    buffer_load_ushort v23, v3, s[16:19], s47 offen
    s_lshl_b32 s60, s10, 5
    s_add_u32 s9, s9, 1
    s_and_b32 s10, s9, 255
    s_lshr_b32 s24, s10, 2
    s_and_b32 s25, s10, 3
    s_lshl_b32 s25, s25, 6
    s_add_u32 s24, s24, s25
    s_add_u32 s26, s24, 0
    s_mul_i32 s40, s26, 514
    buffer_load_ushort v24, v3, s[12:15], s40 offen
    buffer_load_ushort v32, v3, s[16:19], s40 offen
    s_add_u32 s26, s24, 512
    s_mul_i32 s41, s26, 514
    buffer_load_ushort v25, v3, s[12:15], s41 offen
    buffer_load_ushort v33, v3, s[16:19], s41 offen
    s_add_u32 s26, s24, 1024
    s_mul_i32 s42, s26, 514
    buffer_load_ushort v26, v3, s[12:15], s42 offen
    buffer_load_ushort v34, v3, s[16:19], s42 offen
    s_add_u32 s26, s24, 1536
    s_mul_i32 s43, s26, 514
    buffer_load_ushort v27, v3, s[12:15], s43 offen
    buffer_load_ushort v35, v3, s[16:19], s43 offen
    s_add_u32 s26, s24, 256
    s_mul_i32 s44, s26, 514
    buffer_load_ushort v28, v3, s[12:15], s44 offen
    buffer_load_ushort v36, v3, s[16:19], s44 offen
    s_add_u32 s26, s24, 768
    s_mul_i32 s45, s26, 514
    buffer_load_ushort v29, v3, s[12:15], s45 offen
    buffer_load_ushort v37, v3, s[16:19], s45 offen
    s_add_u32 s26, s24, 1280
    s_mul_i32 s46, s26, 514
    buffer_load_ushort v30, v3, s[12:15], s46 offen
    buffer_load_ushort v38, v3, s[16:19], s46 offen
    s_add_u32 s26, s24, 1792
    s_mul_i32 s47, s26, 514
    buffer_load_ushort v31, v3, s[12:15], s47 offen
    buffer_load_ushort v39, v3, s[16:19], s47 offen
    s_lshl_b32 s61, s10, 5
    s_add_u32 s9, s9, 1
    s_and_b32 s10, s9, 255
    s_lshr_b32 s24, s10, 2
    s_and_b32 s25, s10, 3
    s_lshl_b32 s25, s25, 6
    s_add_u32 s24, s24, s25
    s_add_u32 s26, s24, 0
    s_mul_i32 s40, s26, 514
    buffer_load_ushort v40, v3, s[12:15], s40 offen
    buffer_load_ushort v48, v3, s[16:19], s40 offen
    s_add_u32 s26, s24, 512
    s_mul_i32 s41, s26, 514
    buffer_load_ushort v41, v3, s[12:15], s41 offen
    buffer_load_ushort v49, v3, s[16:19], s41 offen
    s_add_u32 s26, s24, 1024
    s_mul_i32 s42, s26, 514
    buffer_load_ushort v42, v3, s[12:15], s42 offen
    buffer_load_ushort v50, v3, s[16:19], s42 offen
    s_add_u32 s26, s24, 1536
    s_mul_i32 s43, s26, 514
    buffer_load_ushort v43, v3, s[12:15], s43 offen
    buffer_load_ushort v51, v3, s[16:19], s43 offen
    s_add_u32 s26, s24, 256
    s_mul_i32 s44, s26, 514
    buffer_load_ushort v44, v3, s[12:15], s44 offen
    buffer_load_ushort v52, v3, s[16:19], s44 offen
    s_add_u32 s26, s24, 768
    s_mul_i32 s45, s26, 514
    buffer_load_ushort v45, v3, s[12:15], s45 offen
    buffer_load_ushort v53, v3, s[16:19], s45 offen
    s_add_u32 s26, s24, 1280
    s_mul_i32 s46, s26, 514
    buffer_load_ushort v46, v3, s[12:15], s46 offen
    buffer_load_ushort v54, v3, s[16:19], s46 offen
    s_add_u32 s26, s24, 1792
    s_mul_i32 s47, s26, 514
    buffer_load_ushort v47, v3, s[12:15], s47 offen
    buffer_load_ushort v55, v3, s[16:19], s47 offen
    s_lshl_b32 s62, s10, 5
    s_add_u32 s9, s9, 1
    s_and_b32 s10, s9, 255
    s_lshr_b32 s24, s10, 2
    s_and_b32 s25, s10, 3
    s_lshl_b32 s25, s25, 6
    s_add_u32 s24, s24, s25
    s_add_u32 s26, s24, 0
    s_mul_i32 s40, s26, 514
    buffer_load_ushort v56, v3, s[12:15], s40 offen
    buffer_load_ushort v64, v3, s[16:19], s40 offen
    s_add_u32 s26, s24, 512
    s_mul_i32 s41, s26, 514
    buffer_load_ushort v57, v3, s[12:15], s41 offen
    buffer_load_ushort v65, v3, s[16:19], s41 offen
    s_add_u32 s26, s24, 1024
    s_mul_i32 s42, s26, 514
    buffer_load_ushort v58, v3, s[12:15], s42 offen
    buffer_load_ushort v66, v3, s[16:19], s42 offen
    s_add_u32 s26, s24, 1536
    s_mul_i32 s43, s26, 514
    buffer_load_ushort v59, v3, s[12:15], s43 offen
    buffer_load_ushort v67, v3, s[16:19], s43 offen
    s_add_u32 s26, s24, 256
    s_mul_i32 s44, s26, 514
    buffer_load_ushort v60, v3, s[12:15], s44 offen
    buffer_load_ushort v68, v3, s[16:19], s44 offen
    s_add_u32 s26, s24, 768
    s_mul_i32 s45, s26, 514
    buffer_load_ushort v61, v3, s[12:15], s45 offen
    buffer_load_ushort v69, v3, s[16:19], s45 offen
    s_add_u32 s26, s24, 1280
    s_mul_i32 s46, s26, 514
    buffer_load_ushort v62, v3, s[12:15], s46 offen
    buffer_load_ushort v70, v3, s[16:19], s46 offen
    s_add_u32 s26, s24, 1792
    s_mul_i32 s47, s26, 514
    buffer_load_ushort v63, v3, s[12:15], s47 offen
    buffer_load_ushort v71, v3, s[16:19], s47 offen
    s_lshl_b32 s63, s10, 5
    s_add_u32 s9, s9, 1
    v_lshlrev_b32 v4, 13, v2
    v_cmp_gt_u32 vcc, 257, v2
    s_and_saveexec_b64 s[34:35], vcc
    s_waitcnt vmcnt(48)
    v_lshl_or_b32 v8, v16, 16, v8
    v_lshl_or_b32 v9, v17, 16, v9
    v_lshl_or_b32 v10, v18, 16, v10
    v_lshl_or_b32 v11, v19, 16, v11
    v_lshl_or_b32 v12, v20, 16, v12
    v_lshl_or_b32 v13, v21, 16, v13
    v_lshl_or_b32 v14, v22, 16, v14
    v_lshl_or_b32 v15, v23, 16, v15
    s_waitcnt vmcnt(32)
    v_lshl_or_b32 v24, v32, 16, v24
    v_lshl_or_b32 v25, v33, 16, v25
    v_lshl_or_b32 v26, v34, 16, v26
    v_lshl_or_b32 v27, v35, 16, v27
    v_lshl_or_b32 v28, v36, 16, v28
    v_lshl_or_b32 v29, v37, 16, v29
    v_lshl_or_b32 v30, v38, 16, v30
    v_lshl_or_b32 v31, v39, 16, v31
    s_waitcnt vmcnt(16)
    v_lshl_or_b32 v40, v48, 16, v40
    v_lshl_or_b32 v41, v49, 16, v41
    v_lshl_or_b32 v42, v50, 16, v42
    v_lshl_or_b32 v43, v51, 16, v43
    v_lshl_or_b32 v44, v52, 16, v44
    v_lshl_or_b32 v45, v53, 16, v45
    v_lshl_or_b32 v46, v54, 16, v46
    v_lshl_or_b32 v47, v55, 16, v47
    s_waitcnt vmcnt(0)
    v_lshl_or_b32 v56, v64, 16, v56
    v_lshl_or_b32 v57, v65, 16, v57
    v_lshl_or_b32 v58, v66, 16, v58
    v_lshl_or_b32 v59, v67, 16, v59
    v_lshl_or_b32 v60, v68, 16, v60
    v_lshl_or_b32 v61, v69, 16, v61
    v_lshl_or_b32 v62, v70, 16, v62
    v_lshl_or_b32 v63, v71, 16, v63
    buffer_store_dwordx4 v[8:11], v4, s[20:23], s60 offen
    buffer_store_dwordx4 v[12:15], v4, s[20:23], s60 offen offset:16
    buffer_store_dwordx4 v[24:27], v4, s[20:23], s61 offen
    buffer_store_dwordx4 v[28:31], v4, s[20:23], s61 offen offset:16
    buffer_store_dwordx4 v[40:43], v4, s[20:23], s62 offen
    buffer_store_dwordx4 v[44:47], v4, s[20:23], s62 offen offset:16
    buffer_store_dwordx4 v[56:59], v4, s[20:23], s63 offen
    buffer_store_dwordx4 v[60:63], v4, s[20:23], s63 offen offset:16
    s_mov_b64 exec, s[34:35]
    s_endpgm
l1_end:
s_endpgm
.section .rodata,"a"
.p2align 6
.amdhsa_kernel l1_kernel
  .amdhsa_next_free_vgpr 176
  .amdhsa_next_free_sgpr 102
  .amdhsa_accum_offset 176
  .amdhsa_group_segment_fixed_size 0
  .amdhsa_kernarg_size 80
  .amdhsa_user_sgpr_count 2
  .amdhsa_user_sgpr_kernarg_segment_ptr 1
  .amdhsa_system_sgpr_workgroup_id_x 1
.end_amdhsa_kernel
.text
.globl l2_kernel
.p2align 8
.type l2_kernel,@function
l2_kernel:
    s_load_dwordx2 s[4:5], s[0:1], 0
    s_load_dwordx2 s[6:7], s[0:1], 72
    s_cmp_ge_u32 s2, 481
    s_cbranch_scc1 l2_end
    s_waitcnt lgkmcnt(0)
    s_cmp_lt_u32 s2, 224
    s_cbranch_scc1 l2_kc_start
    s_branch l2_kb_start
l2_kc_start:
    s_mov_b32 s3, s2
    v_and_b32 v1, 63, v0
    v_lshrrev_b32 v2, 6, v0
    s_nop 0
    v_readfirstlane_b32 s8, v2
    s_and_b32 s28, s3, 7
    s_lshr_b32 s29, s3, 3
    s_lshr_b32 s9, s28, 1
    s_lshl_b32 s9, s9, 2
    s_and_b32 s30, s29, 3
    s_add_u32 s9, s9, s30
    s_and_b32 s10, s28, 1
    s_mul_i32 s10, s10, 7
    s_lshr_b32 s30, s29, 2
    s_add_u32 s10, s10, s30
    s_mov_b32 s12, s6
    s_mov_b32 s13, s7
    s_mov_b32 s14, 0x200000
    s_mov_b32 s15, 0x00020000
    s_add_u32 s16, s6, 0x1800000
    s_addc_u32 s17, s7, 0
    s_mov_b32 s18, 0x380000
    s_mov_b32 s19, 0x00020000
    s_add_u32 s20, s6, 0x2800000
    s_addc_u32 s21, s7, 0
    s_mov_b32 s22, 0x700000
    s_mov_b32 s23, 0x00020000
    s_lshl_b32 s24, s9, 2
    s_add_u32 s24, s24, s8
    s_lshl_b32 s24, s24, 15
    s_lshl_b32 s11, s10, 2
    s_add_u32 s11, s11, s8
    s_lshr_b32 s25, s11, 1
    s_lshl_b32 s25, s25, 17
    s_and_b32 s28, s11, 1
    s_lshl_b32 s28, s28, 10
    s_add_u32 s25, s25, s28
    s_lshl_b32 s26, s8, 12
    s_mov_b32 s44, 0xbfb8aa3b
    s_mov_b32 s45, s44
    s_mov_b32 s46, 1.0
    s_mov_b32 s47, 1.0
    v_lshlrev_b32 v2, 4, v1
    s_add_u32 m0, s26, 0
    s_add_u32 s28, s24, 0
    buffer_load_dwordx4 v2, s[12:15], s28 offen offset:0 lds
    buffer_load_dwordx4 v2, s[12:15], s28 offen offset:1024 lds
    buffer_load_dwordx4 v2, s[12:15], s28 offen offset:2048 lds
    buffer_load_dwordx4 v2, s[12:15], s28 offen offset:3072 lds
    s_add_u32 s29, s25, 0
    buffer_load_dwordx4 v[48:51], v2, s[16:19], s29 offen
    buffer_load_dwordx4 v[52:55], v2, s[16:19], s29 offen offset:2048
    s_add_u32 s29, s25, 4096
    buffer_load_dwordx4 v[56:59], v2, s[16:19], s29 offen
    buffer_load_dwordx4 v[60:63], v2, s[16:19], s29 offen offset:2048
    s_add_u32 s29, s25, 8192
    buffer_load_dwordx4 v[64:67], v2, s[16:19], s29 offen
    buffer_load_dwordx4 v[68:71], v2, s[16:19], s29 offen offset:2048
    s_add_u32 s29, s25, 12288
    buffer_load_dwordx4 v[72:75], v2, s[16:19], s29 offen
    buffer_load_dwordx4 v[76:79], v2, s[16:19], s29 offen offset:2048
    s_add_u32 m0, s26, 16384
    s_add_u32 s28, s24, 4096
    buffer_load_dwordx4 v2, s[12:15], s28 offen offset:0 lds
    buffer_load_dwordx4 v2, s[12:15], s28 offen offset:1024 lds
    buffer_load_dwordx4 v2, s[12:15], s28 offen offset:2048 lds
    buffer_load_dwordx4 v2, s[12:15], s28 offen offset:3072 lds
    s_add_u32 s29, s25, 16384
    buffer_load_dwordx4 v[80:83], v2, s[16:19], s29 offen
    buffer_load_dwordx4 v[84:87], v2, s[16:19], s29 offen offset:2048
    s_add_u32 s29, s25, 20480
    buffer_load_dwordx4 v[88:91], v2, s[16:19], s29 offen
    buffer_load_dwordx4 v[92:95], v2, s[16:19], s29 offen offset:2048
    s_add_u32 s29, s25, 24576
    buffer_load_dwordx4 v[96:99], v2, s[16:19], s29 offen
    buffer_load_dwordx4 v[100:103], v2, s[16:19], s29 offen offset:2048
    s_add_u32 s29, s25, 28672
    buffer_load_dwordx4 v[104:107], v2, s[16:19], s29 offen
    buffer_load_dwordx4 v[108:111], v2, s[16:19], s29 offen offset:2048
    s_add_u32 m0, s26, 32768
    s_add_u32 s28, s24, 8192
    buffer_load_dwordx4 v2, s[12:15], s28 offen offset:0 lds
    buffer_load_dwordx4 v2, s[12:15], s28 offen offset:1024 lds
    buffer_load_dwordx4 v2, s[12:15], s28 offen offset:2048 lds
    buffer_load_dwordx4 v2, s[12:15], s28 offen offset:3072 lds
    s_add_u32 m0, s26, 49152
    s_add_u32 s28, s24, 12288
    buffer_load_dwordx4 v2, s[12:15], s28 offen offset:0 lds
    buffer_load_dwordx4 v2, s[12:15], s28 offen offset:1024 lds
    buffer_load_dwordx4 v2, s[12:15], s28 offen offset:2048 lds
    buffer_load_dwordx4 v2, s[12:15], s28 offen offset:3072 lds
    s_waitcnt vmcnt(28)
    s_barrier
    ds_read_b128 v[16:19], v2 offset:0
    ds_read_b128 v[20:23], v2 offset:4096
    ds_read_b128 v[24:27], v2 offset:8192
    ds_read_b128 v[28:31], v2 offset:12288
    ds_read_b128 v[32:35], v2 offset:1024
    ds_read_b128 v[36:39], v2 offset:5120
    ds_read_b128 v[40:43], v2 offset:9216
    ds_read_b128 v[44:47], v2 offset:13312
    s_waitcnt lgkmcnt(4)
    s_waitcnt vmcnt(27)
    v_mfma_f32_32x32x16_bf16 v[112:127], v[48:51], v[16:19], 0
    s_waitcnt vmcnt(26)
    v_mfma_f32_32x32x16_bf16 v[176:191], v[52:55], v[16:19], 0
    v_mfma_f32_32x32x16_bf16 v[128:143], v[48:51], v[20:23], 0
    v_mfma_f32_32x32x16_bf16 v[192:207], v[52:55], v[20:23], 0
    v_mfma_f32_32x32x16_bf16 v[144:159], v[48:51], v[24:27], 0
    v_mfma_f32_32x32x16_bf16 v[208:223], v[52:55], v[24:27], 0
    v_mfma_f32_32x32x16_bf16 v[160:175], v[48:51], v[28:31], 0
    v_mfma_f32_32x32x16_bf16 v[224:239], v[52:55], v[28:31], 0
    s_add_u32 s29, s25, 32768
    buffer_load_dwordx4 v[48:51], v2, s[16:19], s29 offen
    buffer_load_dwordx4 v[52:55], v2, s[16:19], s29 offen offset:2048
    ds_read_b128 v[16:19], v2 offset:2048
    ds_read_b128 v[20:23], v2 offset:6144
    ds_read_b128 v[24:27], v2 offset:10240
    ds_read_b128 v[28:31], v2 offset:14336
    s_waitcnt lgkmcnt(4)
    s_waitcnt vmcnt(27)
    v_mfma_f32_32x32x16_bf16 v[112:127], v[56:59], v[32:35], v[112:127]
    s_waitcnt vmcnt(26)
    v_mfma_f32_32x32x16_bf16 v[176:191], v[60:63], v[32:35], v[176:191]
    v_mfma_f32_32x32x16_bf16 v[128:143], v[56:59], v[36:39], v[128:143]
    v_mfma_f32_32x32x16_bf16 v[192:207], v[60:63], v[36:39], v[192:207]
    v_mfma_f32_32x32x16_bf16 v[144:159], v[56:59], v[40:43], v[144:159]
    v_mfma_f32_32x32x16_bf16 v[208:223], v[60:63], v[40:43], v[208:223]
    v_mfma_f32_32x32x16_bf16 v[160:175], v[56:59], v[44:47], v[160:175]
    v_mfma_f32_32x32x16_bf16 v[224:239], v[60:63], v[44:47], v[224:239]
    s_add_u32 s29, s25, 36864
    buffer_load_dwordx4 v[56:59], v2, s[16:19], s29 offen
    buffer_load_dwordx4 v[60:63], v2, s[16:19], s29 offen offset:2048
    ds_read_b128 v[32:35], v2 offset:3072
    ds_read_b128 v[36:39], v2 offset:7168
    ds_read_b128 v[40:43], v2 offset:11264
    ds_read_b128 v[44:47], v2 offset:15360
    s_waitcnt lgkmcnt(4)
    s_waitcnt vmcnt(27)
    v_mfma_f32_32x32x16_bf16 v[112:127], v[64:67], v[16:19], v[112:127]
    s_waitcnt vmcnt(26)
    v_mfma_f32_32x32x16_bf16 v[176:191], v[68:71], v[16:19], v[176:191]
    v_mfma_f32_32x32x16_bf16 v[128:143], v[64:67], v[20:23], v[128:143]
    v_mfma_f32_32x32x16_bf16 v[192:207], v[68:71], v[20:23], v[192:207]
    v_mfma_f32_32x32x16_bf16 v[144:159], v[64:67], v[24:27], v[144:159]
    v_mfma_f32_32x32x16_bf16 v[208:223], v[68:71], v[24:27], v[208:223]
    v_mfma_f32_32x32x16_bf16 v[160:175], v[64:67], v[28:31], v[160:175]
    v_mfma_f32_32x32x16_bf16 v[224:239], v[68:71], v[28:31], v[224:239]
    s_add_u32 s29, s25, 40960
    buffer_load_dwordx4 v[64:67], v2, s[16:19], s29 offen
    buffer_load_dwordx4 v[68:71], v2, s[16:19], s29 offen offset:2048
    s_waitcnt vmcnt(22)
    s_barrier
    ds_read_b128 v[16:19], v2 offset:16384
    ds_read_b128 v[20:23], v2 offset:20480
    ds_read_b128 v[24:27], v2 offset:24576
    ds_read_b128 v[28:31], v2 offset:28672
    s_waitcnt lgkmcnt(4)
    s_waitcnt vmcnt(27)
    v_mfma_f32_32x32x16_bf16 v[112:127], v[72:75], v[32:35], v[112:127]
    s_waitcnt vmcnt(26)
    v_mfma_f32_32x32x16_bf16 v[176:191], v[76:79], v[32:35], v[176:191]
    v_mfma_f32_32x32x16_bf16 v[128:143], v[72:75], v[36:39], v[128:143]
    v_mfma_f32_32x32x16_bf16 v[192:207], v[76:79], v[36:39], v[192:207]
    v_mfma_f32_32x32x16_bf16 v[144:159], v[72:75], v[40:43], v[144:159]
    v_mfma_f32_32x32x16_bf16 v[208:223], v[76:79], v[40:43], v[208:223]
    v_mfma_f32_32x32x16_bf16 v[160:175], v[72:75], v[44:47], v[160:175]
    v_mfma_f32_32x32x16_bf16 v[224:239], v[76:79], v[44:47], v[224:239]
    s_add_u32 s29, s25, 45056
    buffer_load_dwordx4 v[72:75], v2, s[16:19], s29 offen
    buffer_load_dwordx4 v[76:79], v2, s[16:19], s29 offen offset:2048
    ds_read_b128 v[32:35], v2 offset:17408
    ds_read_b128 v[36:39], v2 offset:21504
    ds_read_b128 v[40:43], v2 offset:25600
    ds_read_b128 v[44:47], v2 offset:29696
    s_waitcnt lgkmcnt(4)
    s_waitcnt vmcnt(23)
    v_mfma_f32_32x32x16_bf16 v[112:127], v[80:83], v[16:19], v[112:127]
    s_waitcnt vmcnt(22)
    v_mfma_f32_32x32x16_bf16 v[176:191], v[84:87], v[16:19], v[176:191]
    v_mfma_f32_32x32x16_bf16 v[128:143], v[80:83], v[20:23], v[128:143]
    v_mfma_f32_32x32x16_bf16 v[192:207], v[84:87], v[20:23], v[192:207]
    v_mfma_f32_32x32x16_bf16 v[144:159], v[80:83], v[24:27], v[144:159]
    v_mfma_f32_32x32x16_bf16 v[208:223], v[84:87], v[24:27], v[208:223]
    v_mfma_f32_32x32x16_bf16 v[160:175], v[80:83], v[28:31], v[160:175]
    v_mfma_f32_32x32x16_bf16 v[224:239], v[84:87], v[28:31], v[224:239]
    s_add_u32 s29, s25, 49152
    buffer_load_dwordx4 v[80:83], v2, s[16:19], s29 offen
    buffer_load_dwordx4 v[84:87], v2, s[16:19], s29 offen offset:2048
    ds_read_b128 v[16:19], v2 offset:18432
    ds_read_b128 v[20:23], v2 offset:22528
    ds_read_b128 v[24:27], v2 offset:26624
    ds_read_b128 v[28:31], v2 offset:30720
    s_waitcnt lgkmcnt(4)
    s_waitcnt vmcnt(23)
    v_mfma_f32_32x32x16_bf16 v[112:127], v[88:91], v[32:35], v[112:127]
    s_waitcnt vmcnt(22)
    v_mfma_f32_32x32x16_bf16 v[176:191], v[92:95], v[32:35], v[176:191]
    v_mfma_f32_32x32x16_bf16 v[128:143], v[88:91], v[36:39], v[128:143]
    v_mfma_f32_32x32x16_bf16 v[192:207], v[92:95], v[36:39], v[192:207]
    v_mfma_f32_32x32x16_bf16 v[144:159], v[88:91], v[40:43], v[144:159]
    v_mfma_f32_32x32x16_bf16 v[208:223], v[92:95], v[40:43], v[208:223]
    v_mfma_f32_32x32x16_bf16 v[160:175], v[88:91], v[44:47], v[160:175]
    v_mfma_f32_32x32x16_bf16 v[224:239], v[92:95], v[44:47], v[224:239]
    s_add_u32 s29, s25, 53248
    buffer_load_dwordx4 v[88:91], v2, s[16:19], s29 offen
    buffer_load_dwordx4 v[92:95], v2, s[16:19], s29 offen offset:2048
    ds_read_b128 v[32:35], v2 offset:19456
    ds_read_b128 v[36:39], v2 offset:23552
    ds_read_b128 v[40:43], v2 offset:27648
    ds_read_b128 v[44:47], v2 offset:31744
    s_waitcnt lgkmcnt(4)
    s_waitcnt vmcnt(23)
    v_mfma_f32_32x32x16_bf16 v[112:127], v[96:99], v[16:19], v[112:127]
    s_waitcnt vmcnt(22)
    v_mfma_f32_32x32x16_bf16 v[176:191], v[100:103], v[16:19], v[176:191]
    v_mfma_f32_32x32x16_bf16 v[128:143], v[96:99], v[20:23], v[128:143]
    v_mfma_f32_32x32x16_bf16 v[192:207], v[100:103], v[20:23], v[192:207]
    v_mfma_f32_32x32x16_bf16 v[144:159], v[96:99], v[24:27], v[144:159]
    v_mfma_f32_32x32x16_bf16 v[208:223], v[100:103], v[24:27], v[208:223]
    v_mfma_f32_32x32x16_bf16 v[160:175], v[96:99], v[28:31], v[160:175]
    v_mfma_f32_32x32x16_bf16 v[224:239], v[100:103], v[28:31], v[224:239]
    s_add_u32 s29, s25, 57344
    buffer_load_dwordx4 v[96:99], v2, s[16:19], s29 offen
    buffer_load_dwordx4 v[100:103], v2, s[16:19], s29 offen offset:2048
    s_waitcnt vmcnt(18)
    s_barrier
    s_add_u32 m0, s26, 0
    s_add_u32 s28, s24, 16384
    buffer_load_dwordx4 v2, s[12:15], s28 offen offset:0 lds
    buffer_load_dwordx4 v2, s[12:15], s28 offen offset:1024 lds
    buffer_load_dwordx4 v2, s[12:15], s28 offen offset:2048 lds
    buffer_load_dwordx4 v2, s[12:15], s28 offen offset:3072 lds
    ds_read_b128 v[16:19], v2 offset:32768
    ds_read_b128 v[20:23], v2 offset:36864
    ds_read_b128 v[24:27], v2 offset:40960
    ds_read_b128 v[28:31], v2 offset:45056
    s_waitcnt lgkmcnt(4)
    s_waitcnt vmcnt(27)
    v_mfma_f32_32x32x16_bf16 v[112:127], v[104:107], v[32:35], v[112:127]
    s_waitcnt vmcnt(26)
    v_mfma_f32_32x32x16_bf16 v[176:191], v[108:111], v[32:35], v[176:191]
    v_mfma_f32_32x32x16_bf16 v[128:143], v[104:107], v[36:39], v[128:143]
    v_mfma_f32_32x32x16_bf16 v[192:207], v[108:111], v[36:39], v[192:207]
    v_mfma_f32_32x32x16_bf16 v[144:159], v[104:107], v[40:43], v[144:159]
    v_mfma_f32_32x32x16_bf16 v[208:223], v[108:111], v[40:43], v[208:223]
    v_mfma_f32_32x32x16_bf16 v[160:175], v[104:107], v[44:47], v[160:175]
    v_mfma_f32_32x32x16_bf16 v[224:239], v[108:111], v[44:47], v[224:239]
    s_add_u32 s29, s25, 61440
    buffer_load_dwordx4 v[104:107], v2, s[16:19], s29 offen
    buffer_load_dwordx4 v[108:111], v2, s[16:19], s29 offen offset:2048
    ds_read_b128 v[32:35], v2 offset:33792
    ds_read_b128 v[36:39], v2 offset:37888
    ds_read_b128 v[40:43], v2 offset:41984
    ds_read_b128 v[44:47], v2 offset:46080
    s_waitcnt lgkmcnt(4)
    s_waitcnt vmcnt(19)
    v_mfma_f32_32x32x16_bf16 v[112:127], v[48:51], v[16:19], v[112:127]
    s_waitcnt vmcnt(18)
    v_mfma_f32_32x32x16_bf16 v[176:191], v[52:55], v[16:19], v[176:191]
    v_mfma_f32_32x32x16_bf16 v[128:143], v[48:51], v[20:23], v[128:143]
    v_mfma_f32_32x32x16_bf16 v[192:207], v[52:55], v[20:23], v[192:207]
    v_mfma_f32_32x32x16_bf16 v[144:159], v[48:51], v[24:27], v[144:159]
    v_mfma_f32_32x32x16_bf16 v[208:223], v[52:55], v[24:27], v[208:223]
    v_mfma_f32_32x32x16_bf16 v[160:175], v[48:51], v[28:31], v[160:175]
    v_mfma_f32_32x32x16_bf16 v[224:239], v[52:55], v[28:31], v[224:239]
    s_add_u32 s29, s25, 65536
    buffer_load_dwordx4 v[48:51], v2, s[16:19], s29 offen
    buffer_load_dwordx4 v[52:55], v2, s[16:19], s29 offen offset:2048
    ds_read_b128 v[16:19], v2 offset:34816
    ds_read_b128 v[20:23], v2 offset:38912
    ds_read_b128 v[24:27], v2 offset:43008
    ds_read_b128 v[28:31], v2 offset:47104
    s_waitcnt lgkmcnt(4)
    s_waitcnt vmcnt(19)
    v_mfma_f32_32x32x16_bf16 v[112:127], v[56:59], v[32:35], v[112:127]
    s_waitcnt vmcnt(18)
    v_mfma_f32_32x32x16_bf16 v[176:191], v[60:63], v[32:35], v[176:191]
    v_mfma_f32_32x32x16_bf16 v[128:143], v[56:59], v[36:39], v[128:143]
    v_mfma_f32_32x32x16_bf16 v[192:207], v[60:63], v[36:39], v[192:207]
    v_mfma_f32_32x32x16_bf16 v[144:159], v[56:59], v[40:43], v[144:159]
    v_mfma_f32_32x32x16_bf16 v[208:223], v[60:63], v[40:43], v[208:223]
    v_mfma_f32_32x32x16_bf16 v[160:175], v[56:59], v[44:47], v[160:175]
    v_mfma_f32_32x32x16_bf16 v[224:239], v[60:63], v[44:47], v[224:239]
    s_add_u32 s29, s25, 69632
    buffer_load_dwordx4 v[56:59], v2, s[16:19], s29 offen
    buffer_load_dwordx4 v[60:63], v2, s[16:19], s29 offen offset:2048
    ds_read_b128 v[32:35], v2 offset:35840
    ds_read_b128 v[36:39], v2 offset:39936
    ds_read_b128 v[40:43], v2 offset:44032
    ds_read_b128 v[44:47], v2 offset:48128
    s_waitcnt lgkmcnt(4)
    s_waitcnt vmcnt(19)
    v_mfma_f32_32x32x16_bf16 v[112:127], v[64:67], v[16:19], v[112:127]
    s_waitcnt vmcnt(18)
    v_mfma_f32_32x32x16_bf16 v[176:191], v[68:71], v[16:19], v[176:191]
    v_mfma_f32_32x32x16_bf16 v[128:143], v[64:67], v[20:23], v[128:143]
    v_mfma_f32_32x32x16_bf16 v[192:207], v[68:71], v[20:23], v[192:207]
    v_mfma_f32_32x32x16_bf16 v[144:159], v[64:67], v[24:27], v[144:159]
    v_mfma_f32_32x32x16_bf16 v[208:223], v[68:71], v[24:27], v[208:223]
    v_mfma_f32_32x32x16_bf16 v[160:175], v[64:67], v[28:31], v[160:175]
    v_mfma_f32_32x32x16_bf16 v[224:239], v[68:71], v[28:31], v[224:239]
    s_add_u32 s29, s25, 73728
    buffer_load_dwordx4 v[64:67], v2, s[16:19], s29 offen
    buffer_load_dwordx4 v[68:71], v2, s[16:19], s29 offen offset:2048
    s_waitcnt vmcnt(26)
    s_barrier
    s_add_u32 m0, s26, 16384
    s_add_u32 s28, s24, 20480
    buffer_load_dwordx4 v2, s[12:15], s28 offen offset:0 lds
    buffer_load_dwordx4 v2, s[12:15], s28 offen offset:1024 lds
    buffer_load_dwordx4 v2, s[12:15], s28 offen offset:2048 lds
    buffer_load_dwordx4 v2, s[12:15], s28 offen offset:3072 lds
    ds_read_b128 v[16:19], v2 offset:49152
    ds_read_b128 v[20:23], v2 offset:53248
    ds_read_b128 v[24:27], v2 offset:57344
    ds_read_b128 v[28:31], v2 offset:61440
    s_waitcnt lgkmcnt(4)
    s_waitcnt vmcnt(23)
    v_mfma_f32_32x32x16_bf16 v[112:127], v[72:75], v[32:35], v[112:127]
    s_waitcnt vmcnt(22)
    v_mfma_f32_32x32x16_bf16 v[176:191], v[76:79], v[32:35], v[176:191]
    v_mfma_f32_32x32x16_bf16 v[128:143], v[72:75], v[36:39], v[128:143]
    v_mfma_f32_32x32x16_bf16 v[192:207], v[76:79], v[36:39], v[192:207]
    v_mfma_f32_32x32x16_bf16 v[144:159], v[72:75], v[40:43], v[144:159]
    v_mfma_f32_32x32x16_bf16 v[208:223], v[76:79], v[40:43], v[208:223]
    v_mfma_f32_32x32x16_bf16 v[160:175], v[72:75], v[44:47], v[160:175]
    v_mfma_f32_32x32x16_bf16 v[224:239], v[76:79], v[44:47], v[224:239]
    s_add_u32 s29, s25, 77824
    buffer_load_dwordx4 v[72:75], v2, s[16:19], s29 offen
    buffer_load_dwordx4 v[76:79], v2, s[16:19], s29 offen offset:2048
    ds_read_b128 v[32:35], v2 offset:50176
    ds_read_b128 v[36:39], v2 offset:54272
    ds_read_b128 v[40:43], v2 offset:58368
    ds_read_b128 v[44:47], v2 offset:62464
    s_waitcnt lgkmcnt(4)
    s_waitcnt vmcnt(23)
    v_mfma_f32_32x32x16_bf16 v[112:127], v[80:83], v[16:19], v[112:127]
    s_waitcnt vmcnt(22)
    v_mfma_f32_32x32x16_bf16 v[176:191], v[84:87], v[16:19], v[176:191]
    v_mfma_f32_32x32x16_bf16 v[128:143], v[80:83], v[20:23], v[128:143]
    v_mfma_f32_32x32x16_bf16 v[192:207], v[84:87], v[20:23], v[192:207]
    v_mfma_f32_32x32x16_bf16 v[144:159], v[80:83], v[24:27], v[144:159]
    v_mfma_f32_32x32x16_bf16 v[208:223], v[84:87], v[24:27], v[208:223]
    v_mfma_f32_32x32x16_bf16 v[160:175], v[80:83], v[28:31], v[160:175]
    v_mfma_f32_32x32x16_bf16 v[224:239], v[84:87], v[28:31], v[224:239]
    s_add_u32 s29, s25, 81920
    buffer_load_dwordx4 v[80:83], v2, s[16:19], s29 offen
    buffer_load_dwordx4 v[84:87], v2, s[16:19], s29 offen offset:2048
    ds_read_b128 v[16:19], v2 offset:51200
    ds_read_b128 v[20:23], v2 offset:55296
    ds_read_b128 v[24:27], v2 offset:59392
    ds_read_b128 v[28:31], v2 offset:63488
    s_waitcnt lgkmcnt(4)
    s_waitcnt vmcnt(23)
    v_mfma_f32_32x32x16_bf16 v[112:127], v[88:91], v[32:35], v[112:127]
    s_waitcnt vmcnt(22)
    v_mfma_f32_32x32x16_bf16 v[176:191], v[92:95], v[32:35], v[176:191]
    v_mfma_f32_32x32x16_bf16 v[128:143], v[88:91], v[36:39], v[128:143]
    v_mfma_f32_32x32x16_bf16 v[192:207], v[92:95], v[36:39], v[192:207]
    v_mfma_f32_32x32x16_bf16 v[144:159], v[88:91], v[40:43], v[144:159]
    v_mfma_f32_32x32x16_bf16 v[208:223], v[92:95], v[40:43], v[208:223]
    v_mfma_f32_32x32x16_bf16 v[160:175], v[88:91], v[44:47], v[160:175]
    v_mfma_f32_32x32x16_bf16 v[224:239], v[92:95], v[44:47], v[224:239]
    s_add_u32 s29, s25, 86016
    buffer_load_dwordx4 v[88:91], v2, s[16:19], s29 offen
    buffer_load_dwordx4 v[92:95], v2, s[16:19], s29 offen offset:2048
    ds_read_b128 v[32:35], v2 offset:52224
    ds_read_b128 v[36:39], v2 offset:56320
    ds_read_b128 v[40:43], v2 offset:60416
    ds_read_b128 v[44:47], v2 offset:64512
    s_waitcnt lgkmcnt(4)
    s_waitcnt vmcnt(23)
    v_mfma_f32_32x32x16_bf16 v[112:127], v[96:99], v[16:19], v[112:127]
    s_waitcnt vmcnt(22)
    v_mfma_f32_32x32x16_bf16 v[176:191], v[100:103], v[16:19], v[176:191]
    v_mfma_f32_32x32x16_bf16 v[128:143], v[96:99], v[20:23], v[128:143]
    v_mfma_f32_32x32x16_bf16 v[192:207], v[100:103], v[20:23], v[192:207]
    v_mfma_f32_32x32x16_bf16 v[144:159], v[96:99], v[24:27], v[144:159]
    v_mfma_f32_32x32x16_bf16 v[208:223], v[100:103], v[24:27], v[208:223]
    v_mfma_f32_32x32x16_bf16 v[160:175], v[96:99], v[28:31], v[160:175]
    v_mfma_f32_32x32x16_bf16 v[224:239], v[100:103], v[28:31], v[224:239]
    s_add_u32 s29, s25, 90112
    buffer_load_dwordx4 v[96:99], v2, s[16:19], s29 offen
    buffer_load_dwordx4 v[100:103], v2, s[16:19], s29 offen offset:2048
    s_waitcnt vmcnt(20)
    s_barrier
    s_add_u32 m0, s26, 32768
    s_add_u32 s28, s24, 24576
    buffer_load_dwordx4 v2, s[12:15], s28 offen offset:0 lds
    buffer_load_dwordx4 v2, s[12:15], s28 offen offset:1024 lds
    buffer_load_dwordx4 v2, s[12:15], s28 offen offset:2048 lds
    buffer_load_dwordx4 v2, s[12:15], s28 offen offset:3072 lds
    ds_read_b128 v[16:19], v2 offset:0
    ds_read_b128 v[20:23], v2 offset:4096
    ds_read_b128 v[24:27], v2 offset:8192
    ds_read_b128 v[28:31], v2 offset:12288
    s_waitcnt lgkmcnt(4)
    s_waitcnt vmcnt(23)
    v_mfma_f32_32x32x16_bf16 v[112:127], v[104:107], v[32:35], v[112:127]
    s_waitcnt vmcnt(22)
    v_mfma_f32_32x32x16_bf16 v[176:191], v[108:111], v[32:35], v[176:191]
    v_mfma_f32_32x32x16_bf16 v[128:143], v[104:107], v[36:39], v[128:143]
    v_mfma_f32_32x32x16_bf16 v[192:207], v[108:111], v[36:39], v[192:207]
    v_mfma_f32_32x32x16_bf16 v[144:159], v[104:107], v[40:43], v[144:159]
    v_mfma_f32_32x32x16_bf16 v[208:223], v[108:111], v[40:43], v[208:223]
    v_mfma_f32_32x32x16_bf16 v[160:175], v[104:107], v[44:47], v[160:175]
    v_mfma_f32_32x32x16_bf16 v[224:239], v[108:111], v[44:47], v[224:239]
    s_add_u32 s29, s25, 94208
    buffer_load_dwordx4 v[104:107], v2, s[16:19], s29 offen
    buffer_load_dwordx4 v[108:111], v2, s[16:19], s29 offen offset:2048
    ds_read_b128 v[32:35], v2 offset:1024
    ds_read_b128 v[36:39], v2 offset:5120
    ds_read_b128 v[40:43], v2 offset:9216
    ds_read_b128 v[44:47], v2 offset:13312
    s_waitcnt lgkmcnt(4)
    s_waitcnt vmcnt(23)
    v_mfma_f32_32x32x16_bf16 v[112:127], v[48:51], v[16:19], v[112:127]
    s_waitcnt vmcnt(22)
    v_mfma_f32_32x32x16_bf16 v[176:191], v[52:55], v[16:19], v[176:191]
    v_mfma_f32_32x32x16_bf16 v[128:143], v[48:51], v[20:23], v[128:143]
    v_mfma_f32_32x32x16_bf16 v[192:207], v[52:55], v[20:23], v[192:207]
    v_mfma_f32_32x32x16_bf16 v[144:159], v[48:51], v[24:27], v[144:159]
    v_mfma_f32_32x32x16_bf16 v[208:223], v[52:55], v[24:27], v[208:223]
    v_mfma_f32_32x32x16_bf16 v[160:175], v[48:51], v[28:31], v[160:175]
    v_mfma_f32_32x32x16_bf16 v[224:239], v[52:55], v[28:31], v[224:239]
    s_add_u32 s29, s25, 98304
    buffer_load_dwordx4 v[48:51], v2, s[16:19], s29 offen
    buffer_load_dwordx4 v[52:55], v2, s[16:19], s29 offen offset:2048
    ds_read_b128 v[16:19], v2 offset:2048
    ds_read_b128 v[20:23], v2 offset:6144
    ds_read_b128 v[24:27], v2 offset:10240
    ds_read_b128 v[28:31], v2 offset:14336
    s_waitcnt lgkmcnt(4)
    s_waitcnt vmcnt(23)
    v_mfma_f32_32x32x16_bf16 v[112:127], v[56:59], v[32:35], v[112:127]
    s_waitcnt vmcnt(22)
    v_mfma_f32_32x32x16_bf16 v[176:191], v[60:63], v[32:35], v[176:191]
    v_mfma_f32_32x32x16_bf16 v[128:143], v[56:59], v[36:39], v[128:143]
    v_mfma_f32_32x32x16_bf16 v[192:207], v[60:63], v[36:39], v[192:207]
    v_mfma_f32_32x32x16_bf16 v[144:159], v[56:59], v[40:43], v[144:159]
    v_mfma_f32_32x32x16_bf16 v[208:223], v[60:63], v[40:43], v[208:223]
    v_mfma_f32_32x32x16_bf16 v[160:175], v[56:59], v[44:47], v[160:175]
    v_mfma_f32_32x32x16_bf16 v[224:239], v[60:63], v[44:47], v[224:239]
    s_add_u32 s29, s25, 102400
    buffer_load_dwordx4 v[56:59], v2, s[16:19], s29 offen
    buffer_load_dwordx4 v[60:63], v2, s[16:19], s29 offen offset:2048
    ds_read_b128 v[32:35], v2 offset:3072
    ds_read_b128 v[36:39], v2 offset:7168
    ds_read_b128 v[40:43], v2 offset:11264
    ds_read_b128 v[44:47], v2 offset:15360
    s_waitcnt lgkmcnt(4)
    s_waitcnt vmcnt(23)
    v_mfma_f32_32x32x16_bf16 v[112:127], v[64:67], v[16:19], v[112:127]
    s_waitcnt vmcnt(22)
    v_mfma_f32_32x32x16_bf16 v[176:191], v[68:71], v[16:19], v[176:191]
    v_mfma_f32_32x32x16_bf16 v[128:143], v[64:67], v[20:23], v[128:143]
    v_mfma_f32_32x32x16_bf16 v[192:207], v[68:71], v[20:23], v[192:207]
    v_mfma_f32_32x32x16_bf16 v[144:159], v[64:67], v[24:27], v[144:159]
    v_mfma_f32_32x32x16_bf16 v[208:223], v[68:71], v[24:27], v[208:223]
    v_mfma_f32_32x32x16_bf16 v[160:175], v[64:67], v[28:31], v[160:175]
    v_mfma_f32_32x32x16_bf16 v[224:239], v[68:71], v[28:31], v[224:239]
    s_add_u32 s29, s25, 106496
    buffer_load_dwordx4 v[64:67], v2, s[16:19], s29 offen
    buffer_load_dwordx4 v[68:71], v2, s[16:19], s29 offen offset:2048
    s_waitcnt vmcnt(20)
    s_barrier
    s_add_u32 m0, s26, 49152
    s_add_u32 s28, s24, 28672
    buffer_load_dwordx4 v2, s[12:15], s28 offen offset:0 lds
    buffer_load_dwordx4 v2, s[12:15], s28 offen offset:1024 lds
    buffer_load_dwordx4 v2, s[12:15], s28 offen offset:2048 lds
    buffer_load_dwordx4 v2, s[12:15], s28 offen offset:3072 lds
    ds_read_b128 v[16:19], v2 offset:16384
    ds_read_b128 v[20:23], v2 offset:20480
    ds_read_b128 v[24:27], v2 offset:24576
    ds_read_b128 v[28:31], v2 offset:28672
    s_waitcnt lgkmcnt(4)
    s_waitcnt vmcnt(23)
    v_mfma_f32_32x32x16_bf16 v[112:127], v[72:75], v[32:35], v[112:127]
    s_waitcnt vmcnt(22)
    v_mfma_f32_32x32x16_bf16 v[176:191], v[76:79], v[32:35], v[176:191]
    v_mfma_f32_32x32x16_bf16 v[128:143], v[72:75], v[36:39], v[128:143]
    v_mfma_f32_32x32x16_bf16 v[192:207], v[76:79], v[36:39], v[192:207]
    v_mfma_f32_32x32x16_bf16 v[144:159], v[72:75], v[40:43], v[144:159]
    v_mfma_f32_32x32x16_bf16 v[208:223], v[76:79], v[40:43], v[208:223]
    v_mfma_f32_32x32x16_bf16 v[160:175], v[72:75], v[44:47], v[160:175]
    v_mfma_f32_32x32x16_bf16 v[224:239], v[76:79], v[44:47], v[224:239]
    s_add_u32 s29, s25, 110592
    buffer_load_dwordx4 v[72:75], v2, s[16:19], s29 offen
    buffer_load_dwordx4 v[76:79], v2, s[16:19], s29 offen offset:2048
    ds_read_b128 v[32:35], v2 offset:17408
    ds_read_b128 v[36:39], v2 offset:21504
    ds_read_b128 v[40:43], v2 offset:25600
    ds_read_b128 v[44:47], v2 offset:29696
    s_waitcnt lgkmcnt(4)
    s_waitcnt vmcnt(23)
    v_mfma_f32_32x32x16_bf16 v[112:127], v[80:83], v[16:19], v[112:127]
    s_waitcnt vmcnt(22)
    v_mfma_f32_32x32x16_bf16 v[176:191], v[84:87], v[16:19], v[176:191]
    v_mfma_f32_32x32x16_bf16 v[128:143], v[80:83], v[20:23], v[128:143]
    v_mfma_f32_32x32x16_bf16 v[192:207], v[84:87], v[20:23], v[192:207]
    v_mfma_f32_32x32x16_bf16 v[144:159], v[80:83], v[24:27], v[144:159]
    v_mfma_f32_32x32x16_bf16 v[208:223], v[84:87], v[24:27], v[208:223]
    v_mfma_f32_32x32x16_bf16 v[160:175], v[80:83], v[28:31], v[160:175]
    v_mfma_f32_32x32x16_bf16 v[224:239], v[84:87], v[28:31], v[224:239]
    s_add_u32 s29, s25, 114688
    buffer_load_dwordx4 v[80:83], v2, s[16:19], s29 offen
    buffer_load_dwordx4 v[84:87], v2, s[16:19], s29 offen offset:2048
    ds_read_b128 v[16:19], v2 offset:18432
    ds_read_b128 v[20:23], v2 offset:22528
    ds_read_b128 v[24:27], v2 offset:26624
    ds_read_b128 v[28:31], v2 offset:30720
    s_waitcnt lgkmcnt(4)
    s_waitcnt vmcnt(23)
    v_mfma_f32_32x32x16_bf16 v[112:127], v[88:91], v[32:35], v[112:127]
    s_waitcnt vmcnt(22)
    v_mfma_f32_32x32x16_bf16 v[176:191], v[92:95], v[32:35], v[176:191]
    v_mfma_f32_32x32x16_bf16 v[128:143], v[88:91], v[36:39], v[128:143]
    v_mfma_f32_32x32x16_bf16 v[192:207], v[92:95], v[36:39], v[192:207]
    v_mfma_f32_32x32x16_bf16 v[144:159], v[88:91], v[40:43], v[144:159]
    v_mfma_f32_32x32x16_bf16 v[208:223], v[92:95], v[40:43], v[208:223]
    v_mfma_f32_32x32x16_bf16 v[160:175], v[88:91], v[44:47], v[160:175]
    v_mfma_f32_32x32x16_bf16 v[224:239], v[92:95], v[44:47], v[224:239]
    s_add_u32 s29, s25, 118784
    buffer_load_dwordx4 v[88:91], v2, s[16:19], s29 offen
    buffer_load_dwordx4 v[92:95], v2, s[16:19], s29 offen offset:2048
    ds_read_b128 v[32:35], v2 offset:19456
    ds_read_b128 v[36:39], v2 offset:23552
    ds_read_b128 v[40:43], v2 offset:27648
    ds_read_b128 v[44:47], v2 offset:31744
    s_waitcnt lgkmcnt(4)
    s_waitcnt vmcnt(23)
    v_mfma_f32_32x32x16_bf16 v[112:127], v[96:99], v[16:19], v[112:127]
    s_waitcnt vmcnt(22)
    v_mfma_f32_32x32x16_bf16 v[176:191], v[100:103], v[16:19], v[176:191]
    v_mfma_f32_32x32x16_bf16 v[128:143], v[96:99], v[20:23], v[128:143]
    v_mfma_f32_32x32x16_bf16 v[192:207], v[100:103], v[20:23], v[192:207]
    v_mfma_f32_32x32x16_bf16 v[144:159], v[96:99], v[24:27], v[144:159]
    v_mfma_f32_32x32x16_bf16 v[208:223], v[100:103], v[24:27], v[208:223]
    v_mfma_f32_32x32x16_bf16 v[160:175], v[96:99], v[28:31], v[160:175]
    v_mfma_f32_32x32x16_bf16 v[224:239], v[100:103], v[28:31], v[224:239]
    s_add_u32 s29, s25, 122880
    buffer_load_dwordx4 v[96:99], v2, s[16:19], s29 offen
    buffer_load_dwordx4 v[100:103], v2, s[16:19], s29 offen offset:2048
    s_waitcnt vmcnt(20)
    s_barrier
    ds_read_b128 v[16:19], v2 offset:32768
    ds_read_b128 v[20:23], v2 offset:36864
    ds_read_b128 v[24:27], v2 offset:40960
    ds_read_b128 v[28:31], v2 offset:45056
    s_waitcnt lgkmcnt(4)
    s_waitcnt vmcnt(19)
    v_mfma_f32_32x32x16_bf16 v[112:127], v[104:107], v[32:35], v[112:127]
    s_waitcnt vmcnt(18)
    v_mfma_f32_32x32x16_bf16 v[176:191], v[108:111], v[32:35], v[176:191]
    v_mfma_f32_32x32x16_bf16 v[128:143], v[104:107], v[36:39], v[128:143]
    v_mfma_f32_32x32x16_bf16 v[192:207], v[108:111], v[36:39], v[192:207]
    v_mfma_f32_32x32x16_bf16 v[144:159], v[104:107], v[40:43], v[144:159]
    v_mfma_f32_32x32x16_bf16 v[208:223], v[108:111], v[40:43], v[208:223]
    v_mfma_f32_32x32x16_bf16 v[160:175], v[104:107], v[44:47], v[160:175]
    v_mfma_f32_32x32x16_bf16 v[224:239], v[108:111], v[44:47], v[224:239]
    s_add_u32 s29, s25, 126976
    buffer_load_dwordx4 v[104:107], v2, s[16:19], s29 offen
    buffer_load_dwordx4 v[108:111], v2, s[16:19], s29 offen offset:2048
    ds_read_b128 v[32:35], v2 offset:33792
    ds_read_b128 v[36:39], v2 offset:37888
    ds_read_b128 v[40:43], v2 offset:41984
    ds_read_b128 v[44:47], v2 offset:46080
    s_waitcnt lgkmcnt(4)
    s_waitcnt vmcnt(19)
    v_mfma_f32_32x32x16_bf16 v[112:127], v[48:51], v[16:19], v[112:127]
    s_waitcnt vmcnt(18)
    v_mfma_f32_32x32x16_bf16 v[176:191], v[52:55], v[16:19], v[176:191]
    v_mfma_f32_32x32x16_bf16 v[128:143], v[48:51], v[20:23], v[128:143]
    v_mfma_f32_32x32x16_bf16 v[192:207], v[52:55], v[20:23], v[192:207]
    v_mfma_f32_32x32x16_bf16 v[144:159], v[48:51], v[24:27], v[144:159]
    v_mfma_f32_32x32x16_bf16 v[208:223], v[52:55], v[24:27], v[208:223]
    v_mfma_f32_32x32x16_bf16 v[160:175], v[48:51], v[28:31], v[160:175]
    v_mfma_f32_32x32x16_bf16 v[224:239], v[52:55], v[28:31], v[224:239]
    ds_read_b128 v[16:19], v2 offset:34816
    ds_read_b128 v[20:23], v2 offset:38912
    ds_read_b128 v[24:27], v2 offset:43008
    ds_read_b128 v[28:31], v2 offset:47104
    s_waitcnt lgkmcnt(4)
    s_waitcnt vmcnt(17)
    v_mfma_f32_32x32x16_bf16 v[112:127], v[56:59], v[32:35], v[112:127]
    s_waitcnt vmcnt(16)
    v_mfma_f32_32x32x16_bf16 v[176:191], v[60:63], v[32:35], v[176:191]
    v_mfma_f32_32x32x16_bf16 v[128:143], v[56:59], v[36:39], v[128:143]
    v_mfma_f32_32x32x16_bf16 v[192:207], v[60:63], v[36:39], v[192:207]
    v_mfma_f32_32x32x16_bf16 v[144:159], v[56:59], v[40:43], v[144:159]
    v_mfma_f32_32x32x16_bf16 v[208:223], v[60:63], v[40:43], v[208:223]
    v_mfma_f32_32x32x16_bf16 v[160:175], v[56:59], v[44:47], v[160:175]
    v_mfma_f32_32x32x16_bf16 v[224:239], v[60:63], v[44:47], v[224:239]
    ds_read_b128 v[32:35], v2 offset:35840
    ds_read_b128 v[36:39], v2 offset:39936
    ds_read_b128 v[40:43], v2 offset:44032
    ds_read_b128 v[44:47], v2 offset:48128
    s_waitcnt lgkmcnt(4)
    s_waitcnt vmcnt(15)
    v_mfma_f32_32x32x16_bf16 v[112:127], v[64:67], v[16:19], v[112:127]
    s_waitcnt vmcnt(14)
    v_mfma_f32_32x32x16_bf16 v[176:191], v[68:71], v[16:19], v[176:191]
    v_mfma_f32_32x32x16_bf16 v[128:143], v[64:67], v[20:23], v[128:143]
    v_mfma_f32_32x32x16_bf16 v[192:207], v[68:71], v[20:23], v[192:207]
    v_mfma_f32_32x32x16_bf16 v[144:159], v[64:67], v[24:27], v[144:159]
    v_mfma_f32_32x32x16_bf16 v[208:223], v[68:71], v[24:27], v[208:223]
    v_mfma_f32_32x32x16_bf16 v[160:175], v[64:67], v[28:31], v[160:175]
    v_mfma_f32_32x32x16_bf16 v[224:239], v[68:71], v[28:31], v[224:239]
    s_waitcnt vmcnt(10)
    s_barrier
    ds_read_b128 v[16:19], v2 offset:49152
    ds_read_b128 v[20:23], v2 offset:53248
    ds_read_b128 v[24:27], v2 offset:57344
    ds_read_b128 v[28:31], v2 offset:61440
    s_waitcnt lgkmcnt(4)
    s_waitcnt vmcnt(9)
    v_mfma_f32_32x32x16_bf16 v[112:127], v[72:75], v[32:35], v[112:127]
    s_waitcnt vmcnt(8)
    v_mfma_f32_32x32x16_bf16 v[176:191], v[76:79], v[32:35], v[176:191]
    v_mfma_f32_32x32x16_bf16 v[128:143], v[72:75], v[36:39], v[128:143]
    v_mfma_f32_32x32x16_bf16 v[192:207], v[76:79], v[36:39], v[192:207]
    v_mfma_f32_32x32x16_bf16 v[144:159], v[72:75], v[40:43], v[144:159]
    v_mfma_f32_32x32x16_bf16 v[208:223], v[76:79], v[40:43], v[208:223]
    v_mfma_f32_32x32x16_bf16 v[160:175], v[72:75], v[44:47], v[160:175]
    v_mfma_f32_32x32x16_bf16 v[224:239], v[76:79], v[44:47], v[224:239]
    ds_read_b128 v[32:35], v2 offset:50176
    ds_read_b128 v[36:39], v2 offset:54272
    ds_read_b128 v[40:43], v2 offset:58368
    ds_read_b128 v[44:47], v2 offset:62464
    s_waitcnt lgkmcnt(4)
    s_waitcnt vmcnt(7)
    v_mfma_f32_32x32x16_bf16 v[112:127], v[80:83], v[16:19], v[112:127]
    s_waitcnt vmcnt(6)
    v_mfma_f32_32x32x16_bf16 v[176:191], v[84:87], v[16:19], v[176:191]
    v_mfma_f32_32x32x16_bf16 v[128:143], v[80:83], v[20:23], v[128:143]
    v_mfma_f32_32x32x16_bf16 v[192:207], v[84:87], v[20:23], v[192:207]
    v_mfma_f32_32x32x16_bf16 v[144:159], v[80:83], v[24:27], v[144:159]
    v_mfma_f32_32x32x16_bf16 v[208:223], v[84:87], v[24:27], v[208:223]
    v_mfma_f32_32x32x16_bf16 v[160:175], v[80:83], v[28:31], v[160:175]
    v_mfma_f32_32x32x16_bf16 v[224:239], v[84:87], v[28:31], v[224:239]
    ds_read_b128 v[16:19], v2 offset:51200
    ds_read_b128 v[20:23], v2 offset:55296
    ds_read_b128 v[24:27], v2 offset:59392
    ds_read_b128 v[28:31], v2 offset:63488
    s_waitcnt lgkmcnt(4)
    s_waitcnt vmcnt(5)
    v_mfma_f32_32x32x16_bf16 v[112:127], v[88:91], v[32:35], v[112:127]
    s_waitcnt vmcnt(4)
    v_mfma_f32_32x32x16_bf16 v[176:191], v[92:95], v[32:35], v[176:191]
    v_mfma_f32_32x32x16_bf16 v[128:143], v[88:91], v[36:39], v[128:143]
    v_mfma_f32_32x32x16_bf16 v[192:207], v[92:95], v[36:39], v[192:207]
    v_mfma_f32_32x32x16_bf16 v[144:159], v[88:91], v[40:43], v[144:159]
    v_mfma_f32_32x32x16_bf16 v[208:223], v[92:95], v[40:43], v[208:223]
    v_mfma_f32_32x32x16_bf16 v[160:175], v[88:91], v[44:47], v[160:175]
    v_mfma_f32_32x32x16_bf16 v[224:239], v[92:95], v[44:47], v[224:239]
    ds_read_b128 v[32:35], v2 offset:52224
    ds_read_b128 v[36:39], v2 offset:56320
    ds_read_b128 v[40:43], v2 offset:60416
    ds_read_b128 v[44:47], v2 offset:64512
    s_waitcnt lgkmcnt(4)
    s_waitcnt vmcnt(3)
    v_mfma_f32_32x32x16_bf16 v[112:127], v[96:99], v[16:19], v[112:127]
    s_waitcnt vmcnt(2)
    v_mfma_f32_32x32x16_bf16 v[176:191], v[100:103], v[16:19], v[176:191]
    v_mfma_f32_32x32x16_bf16 v[128:143], v[96:99], v[20:23], v[128:143]
    v_mfma_f32_32x32x16_bf16 v[192:207], v[100:103], v[20:23], v[192:207]
    v_mfma_f32_32x32x16_bf16 v[144:159], v[96:99], v[24:27], v[144:159]
    v_mfma_f32_32x32x16_bf16 v[208:223], v[100:103], v[24:27], v[208:223]
    v_mfma_f32_32x32x16_bf16 v[160:175], v[96:99], v[28:31], v[160:175]
    v_mfma_f32_32x32x16_bf16 v[224:239], v[100:103], v[28:31], v[224:239]
    s_waitcnt lgkmcnt(0)
    s_waitcnt vmcnt(1)
    v_mfma_f32_32x32x16_bf16 v[112:127], v[104:107], v[32:35], v[112:127]
    s_waitcnt vmcnt(0)
    v_mfma_f32_32x32x16_bf16 v[176:191], v[108:111], v[32:35], v[176:191]
    v_mfma_f32_32x32x16_bf16 v[128:143], v[104:107], v[36:39], v[128:143]
    v_mfma_f32_32x32x16_bf16 v[192:207], v[108:111], v[36:39], v[192:207]
    v_mfma_f32_32x32x16_bf16 v[144:159], v[104:107], v[40:43], v[144:159]
    v_mfma_f32_32x32x16_bf16 v[208:223], v[108:111], v[40:43], v[208:223]
    v_mfma_f32_32x32x16_bf16 v[160:175], v[104:107], v[44:47], v[160:175]
    v_mfma_f32_32x32x16_bf16 v[224:239], v[108:111], v[44:47], v[224:239]
    v_and_b32 v5, 31, v1
    v_lshlrev_b32 v5, 4, v5
    v_lshrrev_b32 v6, 5, v1
    v_lshlrev_b32 v6, 3, v6
    v_add_u32 v5, v5, v6
    s_lshl_b32 s27, s9, 2
    s_mul_i32 s27, s27, 112
    s_lshl_b32 s28, s11, 1
    s_add_u32 s27, s27, s28
    s_lshl_b32 s27, s27, 10
    s_nop 15
    s_nop 7
    v_cvt_pk_bf16_f32 v20, v112, v113
    v_cvt_pk_bf16_f32 v21, v114, v115
    v_cvt_pk_bf16_f32 v22, v176, v177
    v_cvt_pk_bf16_f32 v23, v178, v179
    v_lshlrev_b32 v112, 16, v20
    v_and_b32 v113, 0xffff0000, v20
    v_lshlrev_b32 v114, 16, v21
    v_and_b32 v115, 0xffff0000, v21
    v_pk_mul_f32 v[16:17], v[112:113], s[44:45]
    v_pk_mul_f32 v[18:19], v[114:115], s[44:45]
    v_exp_f32 v16, v16
    v_exp_f32 v17, v17
    v_exp_f32 v18, v18
    v_exp_f32 v19, v19
    v_lshlrev_b32 v176, 16, v22
    v_and_b32 v177, 0xffff0000, v22
    v_lshlrev_b32 v178, 16, v23
    v_and_b32 v179, 0xffff0000, v23
    v_pk_add_f32 v[16:17], v[16:17], s[46:47]
    v_pk_add_f32 v[18:19], v[18:19], s[46:47]
    v_rcp_f32 v16, v16
    v_rcp_f32 v17, v17
    v_rcp_f32 v18, v18
    v_rcp_f32 v19, v19
    s_nop 0
    v_pk_mul_f32 v[112:113], v[112:113], v[16:17]
    v_pk_mul_f32 v[114:115], v[114:115], v[18:19]
    v_cvt_pk_bf16_f32 v20, v112, v113
    v_cvt_pk_bf16_f32 v21, v114, v115
    v_lshlrev_b32 v112, 16, v20
    v_and_b32 v113, 0xffff0000, v20
    v_lshlrev_b32 v114, 16, v21
    v_and_b32 v115, 0xffff0000, v21
    v_pk_mul_f32 v[112:113], v[112:113], v[176:177]
    v_pk_mul_f32 v[114:115], v[114:115], v[178:179]
    v_cvt_pk_bf16_f32 v24, v112, v113
    v_cvt_pk_bf16_f32 v25, v114, v115
    buffer_store_dwordx2 v[24:25], v5, s[20:23], s27 offen offset:0
    v_cvt_pk_bf16_f32 v20, v116, v117
    v_cvt_pk_bf16_f32 v21, v118, v119
    v_cvt_pk_bf16_f32 v22, v180, v181
    v_cvt_pk_bf16_f32 v23, v182, v183
    v_lshlrev_b32 v116, 16, v20
    v_and_b32 v117, 0xffff0000, v20
    v_lshlrev_b32 v118, 16, v21
    v_and_b32 v119, 0xffff0000, v21
    v_pk_mul_f32 v[16:17], v[116:117], s[44:45]
    v_pk_mul_f32 v[18:19], v[118:119], s[44:45]
    v_exp_f32 v16, v16
    v_exp_f32 v17, v17
    v_exp_f32 v18, v18
    v_exp_f32 v19, v19
    v_lshlrev_b32 v180, 16, v22
    v_and_b32 v181, 0xffff0000, v22
    v_lshlrev_b32 v182, 16, v23
    v_and_b32 v183, 0xffff0000, v23
    v_pk_add_f32 v[16:17], v[16:17], s[46:47]
    v_pk_add_f32 v[18:19], v[18:19], s[46:47]
    v_rcp_f32 v16, v16
    v_rcp_f32 v17, v17
    v_rcp_f32 v18, v18
    v_rcp_f32 v19, v19
    s_nop 0
    v_pk_mul_f32 v[116:117], v[116:117], v[16:17]
    v_pk_mul_f32 v[118:119], v[118:119], v[18:19]
    v_cvt_pk_bf16_f32 v20, v116, v117
    v_cvt_pk_bf16_f32 v21, v118, v119
    v_lshlrev_b32 v116, 16, v20
    v_and_b32 v117, 0xffff0000, v20
    v_lshlrev_b32 v118, 16, v21
    v_and_b32 v119, 0xffff0000, v21
    v_pk_mul_f32 v[116:117], v[116:117], v[180:181]
    v_pk_mul_f32 v[118:119], v[118:119], v[182:183]
    v_cvt_pk_bf16_f32 v26, v116, v117
    v_cvt_pk_bf16_f32 v27, v118, v119
    buffer_store_dwordx2 v[26:27], v5, s[20:23], s27 offen offset:512
    v_cvt_pk_bf16_f32 v20, v120, v121
    v_cvt_pk_bf16_f32 v21, v122, v123
    v_cvt_pk_bf16_f32 v22, v184, v185
    v_cvt_pk_bf16_f32 v23, v186, v187
    v_lshlrev_b32 v120, 16, v20
    v_and_b32 v121, 0xffff0000, v20
    v_lshlrev_b32 v122, 16, v21
    v_and_b32 v123, 0xffff0000, v21
    v_pk_mul_f32 v[16:17], v[120:121], s[44:45]
    v_pk_mul_f32 v[18:19], v[122:123], s[44:45]
    v_exp_f32 v16, v16
    v_exp_f32 v17, v17
    v_exp_f32 v18, v18
    v_exp_f32 v19, v19
    v_lshlrev_b32 v184, 16, v22
    v_and_b32 v185, 0xffff0000, v22
    v_lshlrev_b32 v186, 16, v23
    v_and_b32 v187, 0xffff0000, v23
    v_pk_add_f32 v[16:17], v[16:17], s[46:47]
    v_pk_add_f32 v[18:19], v[18:19], s[46:47]
    v_rcp_f32 v16, v16
    v_rcp_f32 v17, v17
    v_rcp_f32 v18, v18
    v_rcp_f32 v19, v19
    s_nop 0
    v_pk_mul_f32 v[120:121], v[120:121], v[16:17]
    v_pk_mul_f32 v[122:123], v[122:123], v[18:19]
    v_cvt_pk_bf16_f32 v20, v120, v121
    v_cvt_pk_bf16_f32 v21, v122, v123
    v_lshlrev_b32 v120, 16, v20
    v_and_b32 v121, 0xffff0000, v20
    v_lshlrev_b32 v122, 16, v21
    v_and_b32 v123, 0xffff0000, v21
    v_pk_mul_f32 v[120:121], v[120:121], v[184:185]
    v_pk_mul_f32 v[122:123], v[122:123], v[186:187]
    v_cvt_pk_bf16_f32 v28, v120, v121
    v_cvt_pk_bf16_f32 v29, v122, v123
    buffer_store_dwordx2 v[28:29], v5, s[20:23], s27 offen offset:1024
    v_cvt_pk_bf16_f32 v20, v124, v125
    v_cvt_pk_bf16_f32 v21, v126, v127
    v_cvt_pk_bf16_f32 v22, v188, v189
    v_cvt_pk_bf16_f32 v23, v190, v191
    v_lshlrev_b32 v124, 16, v20
    v_and_b32 v125, 0xffff0000, v20
    v_lshlrev_b32 v126, 16, v21
    v_and_b32 v127, 0xffff0000, v21
    v_pk_mul_f32 v[16:17], v[124:125], s[44:45]
    v_pk_mul_f32 v[18:19], v[126:127], s[44:45]
    v_exp_f32 v16, v16
    v_exp_f32 v17, v17
    v_exp_f32 v18, v18
    v_exp_f32 v19, v19
    v_lshlrev_b32 v188, 16, v22
    v_and_b32 v189, 0xffff0000, v22
    v_lshlrev_b32 v190, 16, v23
    v_and_b32 v191, 0xffff0000, v23
    v_pk_add_f32 v[16:17], v[16:17], s[46:47]
    v_pk_add_f32 v[18:19], v[18:19], s[46:47]
    v_rcp_f32 v16, v16
    v_rcp_f32 v17, v17
    v_rcp_f32 v18, v18
    v_rcp_f32 v19, v19
    s_nop 0
    v_pk_mul_f32 v[124:125], v[124:125], v[16:17]
    v_pk_mul_f32 v[126:127], v[126:127], v[18:19]
    v_cvt_pk_bf16_f32 v20, v124, v125
    v_cvt_pk_bf16_f32 v21, v126, v127
    v_lshlrev_b32 v124, 16, v20
    v_and_b32 v125, 0xffff0000, v20
    v_lshlrev_b32 v126, 16, v21
    v_and_b32 v127, 0xffff0000, v21
    v_pk_mul_f32 v[124:125], v[124:125], v[188:189]
    v_pk_mul_f32 v[126:127], v[126:127], v[190:191]
    v_cvt_pk_bf16_f32 v30, v124, v125
    v_cvt_pk_bf16_f32 v31, v126, v127
    buffer_store_dwordx2 v[30:31], v5, s[20:23], s27 offen offset:1536
    s_add_u32 s27, s27, 114688
    v_cvt_pk_bf16_f32 v20, v128, v129
    v_cvt_pk_bf16_f32 v21, v130, v131
    v_cvt_pk_bf16_f32 v22, v192, v193
    v_cvt_pk_bf16_f32 v23, v194, v195
    v_lshlrev_b32 v128, 16, v20
    v_and_b32 v129, 0xffff0000, v20
    v_lshlrev_b32 v130, 16, v21
    v_and_b32 v131, 0xffff0000, v21
    v_pk_mul_f32 v[16:17], v[128:129], s[44:45]
    v_pk_mul_f32 v[18:19], v[130:131], s[44:45]
    v_exp_f32 v16, v16
    v_exp_f32 v17, v17
    v_exp_f32 v18, v18
    v_exp_f32 v19, v19
    v_lshlrev_b32 v192, 16, v22
    v_and_b32 v193, 0xffff0000, v22
    v_lshlrev_b32 v194, 16, v23
    v_and_b32 v195, 0xffff0000, v23
    v_pk_add_f32 v[16:17], v[16:17], s[46:47]
    v_pk_add_f32 v[18:19], v[18:19], s[46:47]
    v_rcp_f32 v16, v16
    v_rcp_f32 v17, v17
    v_rcp_f32 v18, v18
    v_rcp_f32 v19, v19
    s_nop 0
    v_pk_mul_f32 v[128:129], v[128:129], v[16:17]
    v_pk_mul_f32 v[130:131], v[130:131], v[18:19]
    v_cvt_pk_bf16_f32 v20, v128, v129
    v_cvt_pk_bf16_f32 v21, v130, v131
    v_lshlrev_b32 v128, 16, v20
    v_and_b32 v129, 0xffff0000, v20
    v_lshlrev_b32 v130, 16, v21
    v_and_b32 v131, 0xffff0000, v21
    v_pk_mul_f32 v[128:129], v[128:129], v[192:193]
    v_pk_mul_f32 v[130:131], v[130:131], v[194:195]
    v_cvt_pk_bf16_f32 v32, v128, v129
    v_cvt_pk_bf16_f32 v33, v130, v131
    buffer_store_dwordx2 v[32:33], v5, s[20:23], s27 offen offset:0
    v_cvt_pk_bf16_f32 v20, v132, v133
    v_cvt_pk_bf16_f32 v21, v134, v135
    v_cvt_pk_bf16_f32 v22, v196, v197
    v_cvt_pk_bf16_f32 v23, v198, v199
    v_lshlrev_b32 v132, 16, v20
    v_and_b32 v133, 0xffff0000, v20
    v_lshlrev_b32 v134, 16, v21
    v_and_b32 v135, 0xffff0000, v21
    v_pk_mul_f32 v[16:17], v[132:133], s[44:45]
    v_pk_mul_f32 v[18:19], v[134:135], s[44:45]
    v_exp_f32 v16, v16
    v_exp_f32 v17, v17
    v_exp_f32 v18, v18
    v_exp_f32 v19, v19
    v_lshlrev_b32 v196, 16, v22
    v_and_b32 v197, 0xffff0000, v22
    v_lshlrev_b32 v198, 16, v23
    v_and_b32 v199, 0xffff0000, v23
    v_pk_add_f32 v[16:17], v[16:17], s[46:47]
    v_pk_add_f32 v[18:19], v[18:19], s[46:47]
    v_rcp_f32 v16, v16
    v_rcp_f32 v17, v17
    v_rcp_f32 v18, v18
    v_rcp_f32 v19, v19
    s_nop 0
    v_pk_mul_f32 v[132:133], v[132:133], v[16:17]
    v_pk_mul_f32 v[134:135], v[134:135], v[18:19]
    v_cvt_pk_bf16_f32 v20, v132, v133
    v_cvt_pk_bf16_f32 v21, v134, v135
    v_lshlrev_b32 v132, 16, v20
    v_and_b32 v133, 0xffff0000, v20
    v_lshlrev_b32 v134, 16, v21
    v_and_b32 v135, 0xffff0000, v21
    v_pk_mul_f32 v[132:133], v[132:133], v[196:197]
    v_pk_mul_f32 v[134:135], v[134:135], v[198:199]
    v_cvt_pk_bf16_f32 v34, v132, v133
    v_cvt_pk_bf16_f32 v35, v134, v135
    buffer_store_dwordx2 v[34:35], v5, s[20:23], s27 offen offset:512
    v_cvt_pk_bf16_f32 v20, v136, v137
    v_cvt_pk_bf16_f32 v21, v138, v139
    v_cvt_pk_bf16_f32 v22, v200, v201
    v_cvt_pk_bf16_f32 v23, v202, v203
    v_lshlrev_b32 v136, 16, v20
    v_and_b32 v137, 0xffff0000, v20
    v_lshlrev_b32 v138, 16, v21
    v_and_b32 v139, 0xffff0000, v21
    v_pk_mul_f32 v[16:17], v[136:137], s[44:45]
    v_pk_mul_f32 v[18:19], v[138:139], s[44:45]
    v_exp_f32 v16, v16
    v_exp_f32 v17, v17
    v_exp_f32 v18, v18
    v_exp_f32 v19, v19
    v_lshlrev_b32 v200, 16, v22
    v_and_b32 v201, 0xffff0000, v22
    v_lshlrev_b32 v202, 16, v23
    v_and_b32 v203, 0xffff0000, v23
    v_pk_add_f32 v[16:17], v[16:17], s[46:47]
    v_pk_add_f32 v[18:19], v[18:19], s[46:47]
    v_rcp_f32 v16, v16
    v_rcp_f32 v17, v17
    v_rcp_f32 v18, v18
    v_rcp_f32 v19, v19
    s_nop 0
    v_pk_mul_f32 v[136:137], v[136:137], v[16:17]
    v_pk_mul_f32 v[138:139], v[138:139], v[18:19]
    v_cvt_pk_bf16_f32 v20, v136, v137
    v_cvt_pk_bf16_f32 v21, v138, v139
    v_lshlrev_b32 v136, 16, v20
    v_and_b32 v137, 0xffff0000, v20
    v_lshlrev_b32 v138, 16, v21
    v_and_b32 v139, 0xffff0000, v21
    v_pk_mul_f32 v[136:137], v[136:137], v[200:201]
    v_pk_mul_f32 v[138:139], v[138:139], v[202:203]
    v_cvt_pk_bf16_f32 v36, v136, v137
    v_cvt_pk_bf16_f32 v37, v138, v139
    buffer_store_dwordx2 v[36:37], v5, s[20:23], s27 offen offset:1024
    v_cvt_pk_bf16_f32 v20, v140, v141
    v_cvt_pk_bf16_f32 v21, v142, v143
    v_cvt_pk_bf16_f32 v22, v204, v205
    v_cvt_pk_bf16_f32 v23, v206, v207
    v_lshlrev_b32 v140, 16, v20
    v_and_b32 v141, 0xffff0000, v20
    v_lshlrev_b32 v142, 16, v21
    v_and_b32 v143, 0xffff0000, v21
    v_pk_mul_f32 v[16:17], v[140:141], s[44:45]
    v_pk_mul_f32 v[18:19], v[142:143], s[44:45]
    v_exp_f32 v16, v16
    v_exp_f32 v17, v17
    v_exp_f32 v18, v18
    v_exp_f32 v19, v19
    v_lshlrev_b32 v204, 16, v22
    v_and_b32 v205, 0xffff0000, v22
    v_lshlrev_b32 v206, 16, v23
    v_and_b32 v207, 0xffff0000, v23
    v_pk_add_f32 v[16:17], v[16:17], s[46:47]
    v_pk_add_f32 v[18:19], v[18:19], s[46:47]
    v_rcp_f32 v16, v16
    v_rcp_f32 v17, v17
    v_rcp_f32 v18, v18
    v_rcp_f32 v19, v19
    s_nop 0
    v_pk_mul_f32 v[140:141], v[140:141], v[16:17]
    v_pk_mul_f32 v[142:143], v[142:143], v[18:19]
    v_cvt_pk_bf16_f32 v20, v140, v141
    v_cvt_pk_bf16_f32 v21, v142, v143
    v_lshlrev_b32 v140, 16, v20
    v_and_b32 v141, 0xffff0000, v20
    v_lshlrev_b32 v142, 16, v21
    v_and_b32 v143, 0xffff0000, v21
    v_pk_mul_f32 v[140:141], v[140:141], v[204:205]
    v_pk_mul_f32 v[142:143], v[142:143], v[206:207]
    v_cvt_pk_bf16_f32 v38, v140, v141
    v_cvt_pk_bf16_f32 v39, v142, v143
    buffer_store_dwordx2 v[38:39], v5, s[20:23], s27 offen offset:1536
    s_add_u32 s27, s27, 114688
    v_cvt_pk_bf16_f32 v20, v144, v145
    v_cvt_pk_bf16_f32 v21, v146, v147
    v_cvt_pk_bf16_f32 v22, v208, v209
    v_cvt_pk_bf16_f32 v23, v210, v211
    v_lshlrev_b32 v144, 16, v20
    v_and_b32 v145, 0xffff0000, v20
    v_lshlrev_b32 v146, 16, v21
    v_and_b32 v147, 0xffff0000, v21
    v_pk_mul_f32 v[16:17], v[144:145], s[44:45]
    v_pk_mul_f32 v[18:19], v[146:147], s[44:45]
    v_exp_f32 v16, v16
    v_exp_f32 v17, v17
    v_exp_f32 v18, v18
    v_exp_f32 v19, v19
    v_lshlrev_b32 v208, 16, v22
    v_and_b32 v209, 0xffff0000, v22
    v_lshlrev_b32 v210, 16, v23
    v_and_b32 v211, 0xffff0000, v23
    v_pk_add_f32 v[16:17], v[16:17], s[46:47]
    v_pk_add_f32 v[18:19], v[18:19], s[46:47]
    v_rcp_f32 v16, v16
    v_rcp_f32 v17, v17
    v_rcp_f32 v18, v18
    v_rcp_f32 v19, v19
    s_nop 0
    v_pk_mul_f32 v[144:145], v[144:145], v[16:17]
    v_pk_mul_f32 v[146:147], v[146:147], v[18:19]
    v_cvt_pk_bf16_f32 v20, v144, v145
    v_cvt_pk_bf16_f32 v21, v146, v147
    v_lshlrev_b32 v144, 16, v20
    v_and_b32 v145, 0xffff0000, v20
    v_lshlrev_b32 v146, 16, v21
    v_and_b32 v147, 0xffff0000, v21
    v_pk_mul_f32 v[144:145], v[144:145], v[208:209]
    v_pk_mul_f32 v[146:147], v[146:147], v[210:211]
    v_cvt_pk_bf16_f32 v24, v144, v145
    v_cvt_pk_bf16_f32 v25, v146, v147
    buffer_store_dwordx2 v[24:25], v5, s[20:23], s27 offen offset:0
    v_cvt_pk_bf16_f32 v20, v148, v149
    v_cvt_pk_bf16_f32 v21, v150, v151
    v_cvt_pk_bf16_f32 v22, v212, v213
    v_cvt_pk_bf16_f32 v23, v214, v215
    v_lshlrev_b32 v148, 16, v20
    v_and_b32 v149, 0xffff0000, v20
    v_lshlrev_b32 v150, 16, v21
    v_and_b32 v151, 0xffff0000, v21
    v_pk_mul_f32 v[16:17], v[148:149], s[44:45]
    v_pk_mul_f32 v[18:19], v[150:151], s[44:45]
    v_exp_f32 v16, v16
    v_exp_f32 v17, v17
    v_exp_f32 v18, v18
    v_exp_f32 v19, v19
    v_lshlrev_b32 v212, 16, v22
    v_and_b32 v213, 0xffff0000, v22
    v_lshlrev_b32 v214, 16, v23
    v_and_b32 v215, 0xffff0000, v23
    v_pk_add_f32 v[16:17], v[16:17], s[46:47]
    v_pk_add_f32 v[18:19], v[18:19], s[46:47]
    v_rcp_f32 v16, v16
    v_rcp_f32 v17, v17
    v_rcp_f32 v18, v18
    v_rcp_f32 v19, v19
    s_nop 0
    v_pk_mul_f32 v[148:149], v[148:149], v[16:17]
    v_pk_mul_f32 v[150:151], v[150:151], v[18:19]
    v_cvt_pk_bf16_f32 v20, v148, v149
    v_cvt_pk_bf16_f32 v21, v150, v151
    v_lshlrev_b32 v148, 16, v20
    v_and_b32 v149, 0xffff0000, v20
    v_lshlrev_b32 v150, 16, v21
    v_and_b32 v151, 0xffff0000, v21
    v_pk_mul_f32 v[148:149], v[148:149], v[212:213]
    v_pk_mul_f32 v[150:151], v[150:151], v[214:215]
    v_cvt_pk_bf16_f32 v26, v148, v149
    v_cvt_pk_bf16_f32 v27, v150, v151
    buffer_store_dwordx2 v[26:27], v5, s[20:23], s27 offen offset:512
    v_cvt_pk_bf16_f32 v20, v152, v153
    v_cvt_pk_bf16_f32 v21, v154, v155
    v_cvt_pk_bf16_f32 v22, v216, v217
    v_cvt_pk_bf16_f32 v23, v218, v219
    v_lshlrev_b32 v152, 16, v20
    v_and_b32 v153, 0xffff0000, v20
    v_lshlrev_b32 v154, 16, v21
    v_and_b32 v155, 0xffff0000, v21
    v_pk_mul_f32 v[16:17], v[152:153], s[44:45]
    v_pk_mul_f32 v[18:19], v[154:155], s[44:45]
    v_exp_f32 v16, v16
    v_exp_f32 v17, v17
    v_exp_f32 v18, v18
    v_exp_f32 v19, v19
    v_lshlrev_b32 v216, 16, v22
    v_and_b32 v217, 0xffff0000, v22
    v_lshlrev_b32 v218, 16, v23
    v_and_b32 v219, 0xffff0000, v23
    v_pk_add_f32 v[16:17], v[16:17], s[46:47]
    v_pk_add_f32 v[18:19], v[18:19], s[46:47]
    v_rcp_f32 v16, v16
    v_rcp_f32 v17, v17
    v_rcp_f32 v18, v18
    v_rcp_f32 v19, v19
    s_nop 0
    v_pk_mul_f32 v[152:153], v[152:153], v[16:17]
    v_pk_mul_f32 v[154:155], v[154:155], v[18:19]
    v_cvt_pk_bf16_f32 v20, v152, v153
    v_cvt_pk_bf16_f32 v21, v154, v155
    v_lshlrev_b32 v152, 16, v20
    v_and_b32 v153, 0xffff0000, v20
    v_lshlrev_b32 v154, 16, v21
    v_and_b32 v155, 0xffff0000, v21
    v_pk_mul_f32 v[152:153], v[152:153], v[216:217]
    v_pk_mul_f32 v[154:155], v[154:155], v[218:219]
    v_cvt_pk_bf16_f32 v28, v152, v153
    v_cvt_pk_bf16_f32 v29, v154, v155
    buffer_store_dwordx2 v[28:29], v5, s[20:23], s27 offen offset:1024
    v_cvt_pk_bf16_f32 v20, v156, v157
    v_cvt_pk_bf16_f32 v21, v158, v159
    v_cvt_pk_bf16_f32 v22, v220, v221
    v_cvt_pk_bf16_f32 v23, v222, v223
    v_lshlrev_b32 v156, 16, v20
    v_and_b32 v157, 0xffff0000, v20
    v_lshlrev_b32 v158, 16, v21
    v_and_b32 v159, 0xffff0000, v21
    v_pk_mul_f32 v[16:17], v[156:157], s[44:45]
    v_pk_mul_f32 v[18:19], v[158:159], s[44:45]
    v_exp_f32 v16, v16
    v_exp_f32 v17, v17
    v_exp_f32 v18, v18
    v_exp_f32 v19, v19
    v_lshlrev_b32 v220, 16, v22
    v_and_b32 v221, 0xffff0000, v22
    v_lshlrev_b32 v222, 16, v23
    v_and_b32 v223, 0xffff0000, v23
    v_pk_add_f32 v[16:17], v[16:17], s[46:47]
    v_pk_add_f32 v[18:19], v[18:19], s[46:47]
    v_rcp_f32 v16, v16
    v_rcp_f32 v17, v17
    v_rcp_f32 v18, v18
    v_rcp_f32 v19, v19
    s_nop 0
    v_pk_mul_f32 v[156:157], v[156:157], v[16:17]
    v_pk_mul_f32 v[158:159], v[158:159], v[18:19]
    v_cvt_pk_bf16_f32 v20, v156, v157
    v_cvt_pk_bf16_f32 v21, v158, v159
    v_lshlrev_b32 v156, 16, v20
    v_and_b32 v157, 0xffff0000, v20
    v_lshlrev_b32 v158, 16, v21
    v_and_b32 v159, 0xffff0000, v21
    v_pk_mul_f32 v[156:157], v[156:157], v[220:221]
    v_pk_mul_f32 v[158:159], v[158:159], v[222:223]
    v_cvt_pk_bf16_f32 v30, v156, v157
    v_cvt_pk_bf16_f32 v31, v158, v159
    buffer_store_dwordx2 v[30:31], v5, s[20:23], s27 offen offset:1536
    s_add_u32 s27, s27, 114688
    v_cvt_pk_bf16_f32 v20, v160, v161
    v_cvt_pk_bf16_f32 v21, v162, v163
    v_cvt_pk_bf16_f32 v22, v224, v225
    v_cvt_pk_bf16_f32 v23, v226, v227
    v_lshlrev_b32 v160, 16, v20
    v_and_b32 v161, 0xffff0000, v20
    v_lshlrev_b32 v162, 16, v21
    v_and_b32 v163, 0xffff0000, v21
    v_pk_mul_f32 v[16:17], v[160:161], s[44:45]
    v_pk_mul_f32 v[18:19], v[162:163], s[44:45]
    v_exp_f32 v16, v16
    v_exp_f32 v17, v17
    v_exp_f32 v18, v18
    v_exp_f32 v19, v19
    v_lshlrev_b32 v224, 16, v22
    v_and_b32 v225, 0xffff0000, v22
    v_lshlrev_b32 v226, 16, v23
    v_and_b32 v227, 0xffff0000, v23
    v_pk_add_f32 v[16:17], v[16:17], s[46:47]
    v_pk_add_f32 v[18:19], v[18:19], s[46:47]
    v_rcp_f32 v16, v16
    v_rcp_f32 v17, v17
    v_rcp_f32 v18, v18
    v_rcp_f32 v19, v19
    s_nop 0
    v_pk_mul_f32 v[160:161], v[160:161], v[16:17]
    v_pk_mul_f32 v[162:163], v[162:163], v[18:19]
    v_cvt_pk_bf16_f32 v20, v160, v161
    v_cvt_pk_bf16_f32 v21, v162, v163
    v_lshlrev_b32 v160, 16, v20
    v_and_b32 v161, 0xffff0000, v20
    v_lshlrev_b32 v162, 16, v21
    v_and_b32 v163, 0xffff0000, v21
    v_pk_mul_f32 v[160:161], v[160:161], v[224:225]
    v_pk_mul_f32 v[162:163], v[162:163], v[226:227]
    v_cvt_pk_bf16_f32 v32, v160, v161
    v_cvt_pk_bf16_f32 v33, v162, v163
    buffer_store_dwordx2 v[32:33], v5, s[20:23], s27 offen offset:0
    v_cvt_pk_bf16_f32 v20, v164, v165
    v_cvt_pk_bf16_f32 v21, v166, v167
    v_cvt_pk_bf16_f32 v22, v228, v229
    v_cvt_pk_bf16_f32 v23, v230, v231
    v_lshlrev_b32 v164, 16, v20
    v_and_b32 v165, 0xffff0000, v20
    v_lshlrev_b32 v166, 16, v21
    v_and_b32 v167, 0xffff0000, v21
    v_pk_mul_f32 v[16:17], v[164:165], s[44:45]
    v_pk_mul_f32 v[18:19], v[166:167], s[44:45]
    v_exp_f32 v16, v16
    v_exp_f32 v17, v17
    v_exp_f32 v18, v18
    v_exp_f32 v19, v19
    v_lshlrev_b32 v228, 16, v22
    v_and_b32 v229, 0xffff0000, v22
    v_lshlrev_b32 v230, 16, v23
    v_and_b32 v231, 0xffff0000, v23
    v_pk_add_f32 v[16:17], v[16:17], s[46:47]
    v_pk_add_f32 v[18:19], v[18:19], s[46:47]
    v_rcp_f32 v16, v16
    v_rcp_f32 v17, v17
    v_rcp_f32 v18, v18
    v_rcp_f32 v19, v19
    s_nop 0
    v_pk_mul_f32 v[164:165], v[164:165], v[16:17]
    v_pk_mul_f32 v[166:167], v[166:167], v[18:19]
    v_cvt_pk_bf16_f32 v20, v164, v165
    v_cvt_pk_bf16_f32 v21, v166, v167
    v_lshlrev_b32 v164, 16, v20
    v_and_b32 v165, 0xffff0000, v20
    v_lshlrev_b32 v166, 16, v21
    v_and_b32 v167, 0xffff0000, v21
    v_pk_mul_f32 v[164:165], v[164:165], v[228:229]
    v_pk_mul_f32 v[166:167], v[166:167], v[230:231]
    v_cvt_pk_bf16_f32 v34, v164, v165
    v_cvt_pk_bf16_f32 v35, v166, v167
    buffer_store_dwordx2 v[34:35], v5, s[20:23], s27 offen offset:512
    v_cvt_pk_bf16_f32 v20, v168, v169
    v_cvt_pk_bf16_f32 v21, v170, v171
    v_cvt_pk_bf16_f32 v22, v232, v233
    v_cvt_pk_bf16_f32 v23, v234, v235
    v_lshlrev_b32 v168, 16, v20
    v_and_b32 v169, 0xffff0000, v20
    v_lshlrev_b32 v170, 16, v21
    v_and_b32 v171, 0xffff0000, v21
    v_pk_mul_f32 v[16:17], v[168:169], s[44:45]
    v_pk_mul_f32 v[18:19], v[170:171], s[44:45]
    v_exp_f32 v16, v16
    v_exp_f32 v17, v17
    v_exp_f32 v18, v18
    v_exp_f32 v19, v19
    v_lshlrev_b32 v232, 16, v22
    v_and_b32 v233, 0xffff0000, v22
    v_lshlrev_b32 v234, 16, v23
    v_and_b32 v235, 0xffff0000, v23
    v_pk_add_f32 v[16:17], v[16:17], s[46:47]
    v_pk_add_f32 v[18:19], v[18:19], s[46:47]
    v_rcp_f32 v16, v16
    v_rcp_f32 v17, v17
    v_rcp_f32 v18, v18
    v_rcp_f32 v19, v19
    s_nop 0
    v_pk_mul_f32 v[168:169], v[168:169], v[16:17]
    v_pk_mul_f32 v[170:171], v[170:171], v[18:19]
    v_cvt_pk_bf16_f32 v20, v168, v169
    v_cvt_pk_bf16_f32 v21, v170, v171
    v_lshlrev_b32 v168, 16, v20
    v_and_b32 v169, 0xffff0000, v20
    v_lshlrev_b32 v170, 16, v21
    v_and_b32 v171, 0xffff0000, v21
    v_pk_mul_f32 v[168:169], v[168:169], v[232:233]
    v_pk_mul_f32 v[170:171], v[170:171], v[234:235]
    v_cvt_pk_bf16_f32 v36, v168, v169
    v_cvt_pk_bf16_f32 v37, v170, v171
    buffer_store_dwordx2 v[36:37], v5, s[20:23], s27 offen offset:1024
    v_cvt_pk_bf16_f32 v20, v172, v173
    v_cvt_pk_bf16_f32 v21, v174, v175
    v_cvt_pk_bf16_f32 v22, v236, v237
    v_cvt_pk_bf16_f32 v23, v238, v239
    v_lshlrev_b32 v172, 16, v20
    v_and_b32 v173, 0xffff0000, v20
    v_lshlrev_b32 v174, 16, v21
    v_and_b32 v175, 0xffff0000, v21
    v_pk_mul_f32 v[16:17], v[172:173], s[44:45]
    v_pk_mul_f32 v[18:19], v[174:175], s[44:45]
    v_exp_f32 v16, v16
    v_exp_f32 v17, v17
    v_exp_f32 v18, v18
    v_exp_f32 v19, v19
    v_lshlrev_b32 v236, 16, v22
    v_and_b32 v237, 0xffff0000, v22
    v_lshlrev_b32 v238, 16, v23
    v_and_b32 v239, 0xffff0000, v23
    v_pk_add_f32 v[16:17], v[16:17], s[46:47]
    v_pk_add_f32 v[18:19], v[18:19], s[46:47]
    v_rcp_f32 v16, v16
    v_rcp_f32 v17, v17
    v_rcp_f32 v18, v18
    v_rcp_f32 v19, v19
    s_nop 0
    v_pk_mul_f32 v[172:173], v[172:173], v[16:17]
    v_pk_mul_f32 v[174:175], v[174:175], v[18:19]
    v_cvt_pk_bf16_f32 v20, v172, v173
    v_cvt_pk_bf16_f32 v21, v174, v175
    v_lshlrev_b32 v172, 16, v20
    v_and_b32 v173, 0xffff0000, v20
    v_lshlrev_b32 v174, 16, v21
    v_and_b32 v175, 0xffff0000, v21
    v_pk_mul_f32 v[172:173], v[172:173], v[236:237]
    v_pk_mul_f32 v[174:175], v[174:175], v[238:239]
    v_cvt_pk_bf16_f32 v38, v172, v173
    v_cvt_pk_bf16_f32 v39, v174, v175
    buffer_store_dwordx2 v[38:39], v5, s[20:23], s27 offen offset:1536
    s_endpgm
l2_kb_start:
    s_sub_u32 s2, s2, 224
    s_mov_b32 s3, s2
    s_add_u32 s12, s6, 0x800000
    s_addc_u32 s13, s7, 0
    s_mov_b32 s14, 0x404000
    s_mov_b32 s15, 0x00020000
    s_add_u32 s16, s6, 0x1000000
    s_addc_u32 s17, s7, 0
    s_mov_b32 s18, 0x202000
    s_mov_b32 s19, 0x00020000
    s_lshl_b32 s9, s3, 14
    v_lshlrev_b32 v2, 3, v0
    s_add_u32 s40, s9, 0
    buffer_load_dwordx2 v[104:105], v2, s[12:15], s40 offen
    s_add_u32 s41, s9, 2048
    buffer_load_dwordx2 v[106:107], v2, s[12:15], s41 offen
    s_add_u32 s42, s9, 4096
    buffer_load_dwordx2 v[108:109], v2, s[12:15], s42 offen
    s_add_u32 s43, s9, 6144
    buffer_load_dwordx2 v[110:111], v2, s[12:15], s43 offen
    s_add_u32 s44, s9, 8192
    buffer_load_dwordx2 v[112:113], v2, s[12:15], s44 offen
    s_add_u32 s45, s9, 10240
    buffer_load_dwordx2 v[114:115], v2, s[12:15], s45 offen
    s_add_u32 s46, s9, 12288
    buffer_load_dwordx2 v[116:117], v2, s[12:15], s46 offen
    s_add_u32 s47, s9, 14336
    buffer_load_dwordx2 v[118:119], v2, s[12:15], s47 offen
    s_lshl_b32 s10, s3, 13
    v_lshlrev_b32 v3, 5, v0
    buffer_load_dwordx4 v[82:85], v3, s[16:19], s10 offen
    buffer_load_dwordx4 v[86:89], v3, s[16:19], s10 offen offset:16
    s_mov_b32 s26, 0x3f3504f3
    v_and_b32 v12, 2047, v0
    v_cvt_f32_u32 v12, v12
    v_mul_f32 v12, 0xba000000, v12
    v_cos_f32 v40, v12
    v_sin_f32 v41, v12
    v_mul_u32_u24 v12, 2, v0
    v_and_b32 v12, 2047, v12
    v_cvt_f32_u32 v12, v12
    v_mul_f32 v12, 0xba000000, v12
    v_cos_f32 v42, v12
    v_sin_f32 v43, v12
    v_mul_u32_u24 v12, 3, v0
    v_and_b32 v12, 2047, v12
    v_cvt_f32_u32 v12, v12
    v_mul_f32 v12, 0xba000000, v12
    v_cos_f32 v44, v12
    v_sin_f32 v45, v12
    v_mul_u32_u24 v12, 4, v0
    v_and_b32 v12, 2047, v12
    v_cvt_f32_u32 v12, v12
    v_mul_f32 v12, 0xba000000, v12
    v_cos_f32 v46, v12
    v_sin_f32 v47, v12
    v_mul_u32_u24 v12, 5, v0
    v_and_b32 v12, 2047, v12
    v_cvt_f32_u32 v12, v12
    v_mul_f32 v12, 0xba000000, v12
    v_cos_f32 v48, v12
    v_sin_f32 v49, v12
    v_mul_u32_u24 v12, 6, v0
    v_and_b32 v12, 2047, v12
    v_cvt_f32_u32 v12, v12
    v_mul_f32 v12, 0xba000000, v12
    v_cos_f32 v50, v12
    v_sin_f32 v51, v12
    v_mul_u32_u24 v12, 7, v0
    v_and_b32 v12, 2047, v12
    v_cvt_f32_u32 v12, v12
    v_mul_f32 v12, 0xba000000, v12
    v_cos_f32 v52, v12
    v_sin_f32 v53, v12
    s_nop 0
    v_and_b32 v13, 31, v0
    v_and_b32 v12, 255, v13
    v_cvt_f32_u32 v12, v12
    v_mul_f32 v12, 0xbb800000, v12
    v_cos_f32 v54, v12
    v_sin_f32 v55, v12
    v_mul_u32_u24 v12, 2, v13
    v_and_b32 v12, 255, v12
    v_cvt_f32_u32 v12, v12
    v_mul_f32 v12, 0xbb800000, v12
    v_cos_f32 v56, v12
    v_sin_f32 v57, v12
    v_mul_u32_u24 v12, 3, v13
    v_and_b32 v12, 255, v12
    v_cvt_f32_u32 v12, v12
    v_mul_f32 v12, 0xbb800000, v12
    v_cos_f32 v58, v12
    v_sin_f32 v59, v12
    v_mul_u32_u24 v12, 4, v13
    v_and_b32 v12, 255, v12
    v_cvt_f32_u32 v12, v12
    v_mul_f32 v12, 0xbb800000, v12
    v_cos_f32 v60, v12
    v_sin_f32 v61, v12
    v_mul_u32_u24 v12, 5, v13
    v_and_b32 v12, 255, v12
    v_cvt_f32_u32 v12, v12
    v_mul_f32 v12, 0xbb800000, v12
    v_cos_f32 v62, v12
    v_sin_f32 v63, v12
    v_mul_u32_u24 v12, 6, v13
    v_and_b32 v12, 255, v12
    v_cvt_f32_u32 v12, v12
    v_mul_f32 v12, 0xbb800000, v12
    v_cos_f32 v64, v12
    v_sin_f32 v65, v12
    v_mul_u32_u24 v12, 7, v13
    v_and_b32 v12, 255, v12
    v_cvt_f32_u32 v12, v12
    v_mul_f32 v12, 0xbb800000, v12
    v_cos_f32 v66, v12
    v_sin_f32 v67, v12
    s_nop 0
    v_and_b32 v14, 3, v0
    v_and_b32 v12, 31, v14
    v_cvt_f32_u32 v12, v12
    v_mul_f32 v12, 0xbd000000, v12
    v_cos_f32 v68, v12
    v_sin_f32 v69, v12
    v_mul_u32_u24 v12, 2, v14
    v_and_b32 v12, 31, v12
    v_cvt_f32_u32 v12, v12
    v_mul_f32 v12, 0xbd000000, v12
    v_cos_f32 v70, v12
    v_sin_f32 v71, v12
    v_mul_u32_u24 v12, 3, v14
    v_and_b32 v12, 31, v12
    v_cvt_f32_u32 v12, v12
    v_mul_f32 v12, 0xbd000000, v12
    v_cos_f32 v72, v12
    v_sin_f32 v73, v12
    v_mul_u32_u24 v12, 4, v14
    v_and_b32 v12, 31, v12
    v_cvt_f32_u32 v12, v12
    v_mul_f32 v12, 0xbd000000, v12
    v_cos_f32 v74, v12
    v_sin_f32 v75, v12
    v_mul_u32_u24 v12, 5, v14
    v_and_b32 v12, 31, v12
    v_cvt_f32_u32 v12, v12
    v_mul_f32 v12, 0xbd000000, v12
    v_cos_f32 v76, v12
    v_sin_f32 v77, v12
    v_mul_u32_u24 v12, 6, v14
    v_and_b32 v12, 31, v12
    v_cvt_f32_u32 v12, v12
    v_mul_f32 v12, 0xbd000000, v12
    v_cos_f32 v78, v12
    v_sin_f32 v79, v12
    v_mul_u32_u24 v12, 7, v14
    v_and_b32 v12, 31, v12
    v_cvt_f32_u32 v12, v12
    v_mul_f32 v12, 0xbd000000, v12
    v_cos_f32 v80, v12
    v_sin_f32 v81, v12
    s_nop 0
    v_lshrrev_b32 v15, 5, v0
    v_lshlrev_b32 v4, 11, v15
    v_lshlrev_b32 v12, 3, v13
    v_add_u32 v4, v4, v12
    v_mul_u32_u24 v5, 288, v15
    v_add_u32 v5, v5, v12
    v_lshrrev_b32 v15, 2, v0
    v_mul_u32_u24 v6, 288, v15
    v_lshlrev_b32 v12, 3, v14
    v_add_u32 v6, v6, v12
    v_mul_u32_u24 v7, 2056, v14
    v_lshlrev_b32 v12, 5, v15
    v_add_u32 v7, v7, v12
    s_waitcnt vmcnt(2)
    v_add_f32 v120, v104, v112
    v_add_f32 v121, v105, v113
    v_add_f32 v122, v104, -v112
    v_add_f32 v123, v105, -v113
    v_add_f32 v124, v106, v114
    v_add_f32 v125, v107, v115
    v_add_f32 v126, v106, -v114
    v_add_f32 v127, v107, -v115
    v_add_f32 v128, v108, v116
    v_add_f32 v129, v109, v117
    v_add_f32 v130, v108, -v116
    v_add_f32 v131, v109, -v117
    v_add_f32 v132, v110, v118
    v_add_f32 v133, v111, v119
    v_add_f32 v134, v110, -v118
    v_add_f32 v135, v111, -v119
    v_add_f32 v136, v126, v127
    v_add_f32 v137, v127, -v126
    v_mul_f32 v136, s26, v136
    v_mul_f32 v137, s26, v137
    v_add_f32 v138, -v134, v135
    v_add_f32 v139, -v135, -v134
    v_mul_f32 v138, s26, v138
    v_mul_f32 v139, s26, v139
    v_add_f32 v140, v120, v128
    v_add_f32 v141, v121, v129
    v_add_f32 v142, v120, -v128
    v_add_f32 v143, v121, -v129
    v_add_f32 v144, v124, v132
    v_add_f32 v145, v125, v133
    v_add_f32 v146, v124, -v132
    v_add_f32 v147, v125, -v133
    v_add_f32 v148, v140, v144
    v_add_f32 v149, v141, v145
    v_add_f32 v150, v140, -v144
    v_add_f32 v151, v141, -v145
    v_add_f32 v104, v142, v147
    v_add_f32 v105, v143, -v146
    v_add_f32 v112, v142, -v147
    v_add_f32 v113, v143, v146
    v_add_f32 v106, v122, v131
    v_add_f32 v107, v123, -v130
    v_add_f32 v114, v122, -v131
    v_add_f32 v115, v123, v130
    v_add_f32 v108, v136, v138
    v_add_f32 v109, v137, v139
    v_add_f32 v116, v136, -v138
    v_add_f32 v117, v137, -v139
    v_add_f32 v110, v106, v108
    v_add_f32 v111, v107, v109
    v_add_f32 v118, v106, -v108
    v_add_f32 v119, v107, -v109
    v_add_f32 v126, v114, v117
    v_add_f32 v127, v115, -v116
    v_add_f32 v134, v114, -v117
    v_add_f32 v135, v115, v116
    v_mul_f32 v120, v110, v40
    v_fma_f32 v120, -v111, v41, v120
    v_mul_f32 v121, v110, v41
    v_fma_f32 v121, v111, v40, v121
    v_mul_f32 v128, v104, v42
    v_fma_f32 v128, -v105, v43, v128
    v_mul_f32 v129, v104, v43
    v_fma_f32 v129, v105, v42, v129
    v_mul_f32 v124, v126, v44
    v_fma_f32 v124, -v127, v45, v124
    v_mul_f32 v125, v126, v45
    v_fma_f32 v125, v127, v44, v125
    v_mul_f32 v132, v150, v46
    v_fma_f32 v132, -v151, v47, v132
    v_mul_f32 v133, v150, v47
    v_fma_f32 v133, v151, v46, v133
    v_mul_f32 v140, v118, v48
    v_fma_f32 v140, -v119, v49, v140
    v_mul_f32 v141, v118, v49
    v_fma_f32 v141, v119, v48, v141
    v_mul_f32 v144, v112, v50
    v_fma_f32 v144, -v113, v51, v144
    v_mul_f32 v145, v112, v51
    v_fma_f32 v145, v113, v50, v145
    v_mul_f32 v142, v134, v52
    v_fma_f32 v142, -v135, v53, v142
    v_mul_f32 v143, v134, v53
    v_fma_f32 v143, v135, v52, v143
    ds_write_b64 v2, v[148:149] offset:0
    ds_write_b64 v2, v[120:121] offset:2048
    ds_write_b64 v2, v[128:129] offset:4096
    ds_write_b64 v2, v[124:125] offset:6144
    ds_write_b64 v2, v[132:133] offset:8192
    ds_write_b64 v2, v[140:141] offset:10240
    ds_write_b64 v2, v[144:145] offset:12288
    ds_write_b64 v2, v[142:143] offset:14336
    s_waitcnt lgkmcnt(0)
    s_barrier
    ds_read_b64 v[146:147], v4 offset:0
    ds_read_b64 v[122:123], v4 offset:256
    ds_read_b64 v[130:131], v4 offset:512
    ds_read_b64 v[136:137], v4 offset:768
    ds_read_b64 v[138:139], v4 offset:1024
    ds_read_b64 v[106:107], v4 offset:1280
    ds_read_b64 v[108:109], v4 offset:1536
    ds_read_b64 v[114:115], v4 offset:1792
    s_waitcnt lgkmcnt(0)
    v_add_f32 v116, v146, v138
    v_add_f32 v117, v147, v139
    v_add_f32 v110, v146, -v138
    v_add_f32 v111, v147, -v139
    v_add_f32 v104, v122, v106
    v_add_f32 v105, v123, v107
    v_add_f32 v126, v122, -v106
    v_add_f32 v127, v123, -v107
    v_add_f32 v150, v130, v108
    v_add_f32 v151, v131, v109
    v_add_f32 v118, v130, -v108
    v_add_f32 v119, v131, -v109
    v_add_f32 v112, v136, v114
    v_add_f32 v113, v137, v115
    v_add_f32 v134, v136, -v114
    v_add_f32 v135, v137, -v115
    v_add_f32 v148, v126, v127
    v_add_f32 v149, v127, -v126
    v_mul_f32 v148, s26, v148
    v_mul_f32 v149, s26, v149
    v_add_f32 v120, -v134, v135
    v_add_f32 v121, -v135, -v134
    v_mul_f32 v120, s26, v120
    v_mul_f32 v121, s26, v121
    v_add_f32 v128, v116, v150
    v_add_f32 v129, v117, v151
    v_add_f32 v124, v116, -v150
    v_add_f32 v125, v117, -v151
    v_add_f32 v132, v104, v112
    v_add_f32 v133, v105, v113
    v_add_f32 v140, v104, -v112
    v_add_f32 v141, v105, -v113
    v_add_f32 v144, v128, v132
    v_add_f32 v145, v129, v133
    v_add_f32 v142, v128, -v132
    v_add_f32 v143, v129, -v133
    v_add_f32 v146, v124, v141
    v_add_f32 v147, v125, -v140
    v_add_f32 v138, v124, -v141
    v_add_f32 v139, v125, v140
    v_add_f32 v122, v110, v119
    v_add_f32 v123, v111, -v118
    v_add_f32 v106, v110, -v119
    v_add_f32 v107, v111, v118
    v_add_f32 v130, v148, v120
    v_add_f32 v131, v149, v121
    v_add_f32 v108, v148, -v120
    v_add_f32 v109, v149, -v121
    v_add_f32 v136, v122, v130
    v_add_f32 v137, v123, v131
    v_add_f32 v114, v122, -v130
    v_add_f32 v115, v123, -v131
    v_add_f32 v126, v106, v109
    v_add_f32 v127, v107, -v108
    v_add_f32 v134, v106, -v109
    v_add_f32 v135, v107, v108
    v_mul_f32 v116, v136, v54
    v_fma_f32 v116, -v137, v55, v116
    v_mul_f32 v117, v136, v55
    v_fma_f32 v117, v137, v54, v117
    v_mul_f32 v150, v146, v56
    v_fma_f32 v150, -v147, v57, v150
    v_mul_f32 v151, v146, v57
    v_fma_f32 v151, v147, v56, v151
    v_mul_f32 v104, v126, v58
    v_fma_f32 v104, -v127, v59, v104
    v_mul_f32 v105, v126, v59
    v_fma_f32 v105, v127, v58, v105
    v_mul_f32 v112, v142, v60
    v_fma_f32 v112, -v143, v61, v112
    v_mul_f32 v113, v142, v61
    v_fma_f32 v113, v143, v60, v113
    v_mul_f32 v128, v114, v62
    v_fma_f32 v128, -v115, v63, v128
    v_mul_f32 v129, v114, v63
    v_fma_f32 v129, v115, v62, v129
    v_mul_f32 v132, v138, v64
    v_fma_f32 v132, -v139, v65, v132
    v_mul_f32 v133, v138, v65
    v_fma_f32 v133, v139, v64, v133
    v_mul_f32 v124, v134, v66
    v_fma_f32 v124, -v135, v67, v124
    v_mul_f32 v125, v134, v67
    v_fma_f32 v125, v135, v66, v125
    ds_write_b64 v5, v[144:145] offset:18432
    ds_write_b64 v5, v[116:117] offset:20736
    ds_write_b64 v5, v[150:151] offset:23040
    ds_write_b64 v5, v[104:105] offset:25344
    ds_write_b64 v5, v[112:113] offset:27648
    ds_write_b64 v5, v[128:129] offset:29952
    ds_write_b64 v5, v[132:133] offset:32256
    ds_write_b64 v5, v[124:125] offset:34560
    s_waitcnt lgkmcnt(0)
    s_barrier
    ds_read_b64 v[140:141], v6 offset:18432
    ds_read_b64 v[110:111], v6 offset:18464
    ds_read_b64 v[118:119], v6 offset:18496
    ds_read_b64 v[148:149], v6 offset:18528
    ds_read_b64 v[120:121], v6 offset:18560
    ds_read_b64 v[122:123], v6 offset:18592
    ds_read_b64 v[130:131], v6 offset:18624
    ds_read_b64 v[106:107], v6 offset:18656
    s_waitcnt lgkmcnt(0)
    v_add_f32 v108, v140, v120
    v_add_f32 v109, v141, v121
    v_add_f32 v136, v140, -v120
    v_add_f32 v137, v141, -v121
    v_add_f32 v146, v110, v122
    v_add_f32 v147, v111, v123
    v_add_f32 v126, v110, -v122
    v_add_f32 v127, v111, -v123
    v_add_f32 v142, v118, v130
    v_add_f32 v143, v119, v131
    v_add_f32 v114, v118, -v130
    v_add_f32 v115, v119, -v131
    v_add_f32 v138, v148, v106
    v_add_f32 v139, v149, v107
    v_add_f32 v134, v148, -v106
    v_add_f32 v135, v149, -v107
    v_add_f32 v144, v126, v127
    v_add_f32 v145, v127, -v126
    v_mul_f32 v144, s26, v144
    v_mul_f32 v145, s26, v145
    v_add_f32 v116, -v134, v135
    v_add_f32 v117, -v135, -v134
    v_mul_f32 v116, s26, v116
    v_mul_f32 v117, s26, v117
    v_add_f32 v150, v108, v142
    v_add_f32 v151, v109, v143
    v_add_f32 v104, v108, -v142
    v_add_f32 v105, v109, -v143
    v_add_f32 v112, v146, v138
    v_add_f32 v113, v147, v139
    v_add_f32 v128, v146, -v138
    v_add_f32 v129, v147, -v139
    v_add_f32 v132, v150, v112
    v_add_f32 v133, v151, v113
    v_add_f32 v124, v150, -v112
    v_add_f32 v125, v151, -v113
    v_add_f32 v140, v104, v129
    v_add_f32 v141, v105, -v128
    v_add_f32 v120, v104, -v129
    v_add_f32 v121, v105, v128
    v_add_f32 v110, v136, v115
    v_add_f32 v111, v137, -v114
    v_add_f32 v122, v136, -v115
    v_add_f32 v123, v137, v114
    v_add_f32 v118, v144, v116
    v_add_f32 v119, v145, v117
    v_add_f32 v130, v144, -v116
    v_add_f32 v131, v145, -v117
    v_add_f32 v148, v110, v118
    v_add_f32 v149, v111, v119
    v_add_f32 v106, v110, -v118
    v_add_f32 v107, v111, -v119
    v_add_f32 v126, v122, v131
    v_add_f32 v127, v123, -v130
    v_add_f32 v134, v122, -v131
    v_add_f32 v135, v123, v130
    v_mul_f32 v108, v148, v68
    v_fma_f32 v108, -v149, v69, v108
    v_mul_f32 v109, v148, v69
    v_fma_f32 v109, v149, v68, v109
    v_mul_f32 v142, v140, v70
    v_fma_f32 v142, -v141, v71, v142
    v_mul_f32 v143, v140, v71
    v_fma_f32 v143, v141, v70, v143
    v_mul_f32 v146, v126, v72
    v_fma_f32 v146, -v127, v73, v146
    v_mul_f32 v147, v126, v73
    v_fma_f32 v147, v127, v72, v147
    v_mul_f32 v138, v124, v74
    v_fma_f32 v138, -v125, v75, v138
    v_mul_f32 v139, v124, v75
    v_fma_f32 v139, v125, v74, v139
    v_mul_f32 v150, v106, v76
    v_fma_f32 v150, -v107, v77, v150
    v_mul_f32 v151, v106, v77
    v_fma_f32 v151, v107, v76, v151
    v_mul_f32 v112, v120, v78
    v_fma_f32 v112, -v121, v79, v112
    v_mul_f32 v113, v120, v79
    v_fma_f32 v113, v121, v78, v113
    v_mul_f32 v104, v134, v80
    v_fma_f32 v104, -v135, v81, v104
    v_mul_f32 v105, v134, v81
    v_fma_f32 v105, v135, v80, v105
    ds_write_b64 v2, v[132:133] offset:0
    ds_write_b64 v2, v[108:109] offset:2056
    ds_write_b64 v2, v[142:143] offset:4112
    ds_write_b64 v2, v[146:147] offset:6168
    ds_write_b64 v2, v[138:139] offset:8224
    ds_write_b64 v2, v[150:151] offset:10280
    ds_write_b64 v2, v[112:113] offset:12336
    ds_write_b64 v2, v[104:105] offset:14392
    s_waitcnt lgkmcnt(0)
    s_barrier
    ds_read_b64 v[128:129], v7 offset:0
    ds_read_b64 v[136:137], v7 offset:8
    ds_read_b64 v[114:115], v7 offset:16
    ds_read_b64 v[144:145], v7 offset:24
    ds_read_b64 v[116:117], v7 offset:8224
    ds_read_b64 v[110:111], v7 offset:8232
    ds_read_b64 v[118:119], v7 offset:8240
    ds_read_b64 v[122:123], v7 offset:8248
    s_waitcnt lgkmcnt(0)
    v_add_f32 v130, v128, v114
    v_add_f32 v131, v129, v115
    v_add_f32 v148, v128, -v114
    v_add_f32 v149, v129, -v115
    v_add_f32 v140, v136, v144
    v_add_f32 v141, v137, v145
    v_add_f32 v126, v136, -v144
    v_add_f32 v127, v137, -v145
    v_add_f32 v124, v130, v140
    v_add_f32 v125, v131, v141
    v_add_f32 v106, v130, -v140
    v_add_f32 v107, v131, -v141
    v_add_f32 v120, v148, v127
    v_add_f32 v121, v149, -v126
    v_add_f32 v134, v148, -v127
    v_add_f32 v135, v149, v126
    v_add_f32 v132, v116, v118
    v_add_f32 v133, v117, v119
    v_add_f32 v108, v116, -v118
    v_add_f32 v109, v117, -v119
    v_add_f32 v142, v110, v122
    v_add_f32 v143, v111, v123
    v_add_f32 v146, v110, -v122
    v_add_f32 v147, v111, -v123
    v_add_f32 v138, v132, v142
    v_add_f32 v139, v133, v143
    v_add_f32 v150, v132, -v142
    v_add_f32 v151, v133, -v143
    v_add_f32 v112, v108, v147
    v_add_f32 v113, v109, -v146
    v_add_f32 v104, v108, -v147
    v_add_f32 v105, v109, v146
    s_waitcnt vmcnt(0)
    v_lshlrev_b32 v12, 16, v82
    v_and_b32 v13, 0xffff0000, v82
    v_mul_f32 v128, v124, v12
    v_fma_f32 v128, -v125, v13, v128
    v_mul_f32 v129, v124, v13
    v_fma_f32 v129, v125, v12, v129
    v_lshlrev_b32 v12, 16, v83
    v_and_b32 v13, 0xffff0000, v83
    v_mul_f32 v114, v120, v12
    v_fma_f32 v114, -v121, v13, v114
    v_mul_f32 v115, v120, v13
    v_fma_f32 v115, v121, v12, v115
    v_lshlrev_b32 v12, 16, v84
    v_and_b32 v13, 0xffff0000, v84
    v_mul_f32 v136, v106, v12
    v_fma_f32 v136, -v107, v13, v136
    v_mul_f32 v137, v106, v13
    v_fma_f32 v137, v107, v12, v137
    v_lshlrev_b32 v12, 16, v85
    v_and_b32 v13, 0xffff0000, v85
    v_mul_f32 v144, v134, v12
    v_fma_f32 v144, -v135, v13, v144
    v_mul_f32 v145, v134, v13
    v_fma_f32 v145, v135, v12, v145
    v_lshlrev_b32 v12, 16, v86
    v_and_b32 v13, 0xffff0000, v86
    v_mul_f32 v130, v138, v12
    v_fma_f32 v130, -v139, v13, v130
    v_mul_f32 v131, v138, v13
    v_fma_f32 v131, v139, v12, v131
    v_lshlrev_b32 v12, 16, v87
    v_and_b32 v13, 0xffff0000, v87
    v_mul_f32 v140, v112, v12
    v_fma_f32 v140, -v113, v13, v140
    v_mul_f32 v141, v112, v13
    v_fma_f32 v141, v113, v12, v141
    v_lshlrev_b32 v12, 16, v88
    v_and_b32 v13, 0xffff0000, v88
    v_mul_f32 v148, v150, v12
    v_fma_f32 v148, -v151, v13, v148
    v_mul_f32 v149, v150, v13
    v_fma_f32 v149, v151, v12, v149
    v_lshlrev_b32 v12, 16, v89
    v_and_b32 v13, 0xffff0000, v89
    v_mul_f32 v126, v104, v12
    v_fma_f32 v126, -v105, v13, v126
    v_mul_f32 v127, v104, v13
    v_fma_f32 v127, v105, v12, v127
    v_add_f32 v116, v128, v136
    v_add_f32 v117, v129, v137
    v_add_f32 v118, v128, -v136
    v_add_f32 v119, v129, -v137
    v_add_f32 v110, v114, v144
    v_add_f32 v111, v115, v145
    v_add_f32 v122, v114, -v144
    v_add_f32 v123, v115, -v145
    v_add_f32 v132, v116, v110
    v_add_f32 v133, v117, v111
    v_add_f32 v142, v116, -v110
    v_add_f32 v143, v117, -v111
    v_add_f32 v108, v118, -v123
    v_add_f32 v109, v119, v122
    v_add_f32 v146, v118, v123
    v_add_f32 v147, v119, -v122
    v_add_f32 v124, v130, v148
    v_add_f32 v125, v131, v149
    v_add_f32 v120, v130, -v148
    v_add_f32 v121, v131, -v149
    v_add_f32 v106, v140, v126
    v_add_f32 v107, v141, v127
    v_add_f32 v134, v140, -v126
    v_add_f32 v135, v141, -v127
    v_add_f32 v138, v124, v106
    v_add_f32 v139, v125, v107
    v_add_f32 v112, v124, -v106
    v_add_f32 v113, v125, -v107
    v_add_f32 v150, v120, -v135
    v_add_f32 v151, v121, v134
    v_add_f32 v104, v120, v135
    v_add_f32 v105, v121, -v134
    ds_write_b64 v7, v[132:133] offset:18432
    ds_write_b64 v7, v[108:109] offset:18440
    ds_write_b64 v7, v[142:143] offset:18448
    ds_write_b64 v7, v[146:147] offset:18456
    ds_write_b64 v7, v[138:139] offset:26656
    ds_write_b64 v7, v[150:151] offset:26664
    ds_write_b64 v7, v[112:113] offset:26672
    ds_write_b64 v7, v[104:105] offset:26680
    s_waitcnt lgkmcnt(0)
    s_barrier
    ds_read_b64 v[128:129], v2 offset:18432
    ds_read_b64 v[136:137], v2 offset:20488
    ds_read_b64 v[114:115], v2 offset:22544
    ds_read_b64 v[144:145], v2 offset:24600
    ds_read_b64 v[116:117], v2 offset:26656
    ds_read_b64 v[110:111], v2 offset:28712
    ds_read_b64 v[118:119], v2 offset:30768
    ds_read_b64 v[122:123], v2 offset:32824
    s_waitcnt lgkmcnt(0)
    v_mul_f32 v130, v136, v68
    v_fma_f32 v130, v137, v69, v130
    v_mul_f32 v131, v137, v68
    v_fma_f32 v131, -v136, v69, v131
    v_mul_f32 v148, v114, v70
    v_fma_f32 v148, v115, v71, v148
    v_mul_f32 v149, v115, v70
    v_fma_f32 v149, -v114, v71, v149
    v_mul_f32 v140, v144, v72
    v_fma_f32 v140, v145, v73, v140
    v_mul_f32 v141, v145, v72
    v_fma_f32 v141, -v144, v73, v141
    v_mul_f32 v126, v116, v74
    v_fma_f32 v126, v117, v75, v126
    v_mul_f32 v127, v117, v74
    v_fma_f32 v127, -v116, v75, v127
    v_mul_f32 v124, v110, v76
    v_fma_f32 v124, v111, v77, v124
    v_mul_f32 v125, v111, v76
    v_fma_f32 v125, -v110, v77, v125
    v_mul_f32 v106, v118, v78
    v_fma_f32 v106, v119, v79, v106
    v_mul_f32 v107, v119, v78
    v_fma_f32 v107, -v118, v79, v107
    v_mul_f32 v120, v122, v80
    v_fma_f32 v120, v123, v81, v120
    v_mul_f32 v121, v123, v80
    v_fma_f32 v121, -v122, v81, v121
    v_add_f32 v134, v128, v126
    v_add_f32 v135, v129, v127
    v_add_f32 v132, v128, -v126
    v_add_f32 v133, v129, -v127
    v_add_f32 v108, v130, v124
    v_add_f32 v109, v131, v125
    v_add_f32 v142, v130, -v124
    v_add_f32 v143, v131, -v125
    v_add_f32 v146, v148, v106
    v_add_f32 v147, v149, v107
    v_add_f32 v138, v148, -v106
    v_add_f32 v139, v149, -v107
    v_add_f32 v150, v140, v120
    v_add_f32 v151, v141, v121
    v_add_f32 v112, v140, -v120
    v_add_f32 v113, v141, -v121
    v_add_f32 v104, v142, -v143
    v_add_f32 v105, v143, v142
    v_mul_f32 v104, s26, v104
    v_mul_f32 v105, s26, v105
    v_add_f32 v136, -v112, -v113
    v_add_f32 v137, -v113, v112
    v_mul_f32 v136, s26, v136
    v_mul_f32 v137, s26, v137
    v_add_f32 v114, v134, v146
    v_add_f32 v115, v135, v147
    v_add_f32 v144, v134, -v146
    v_add_f32 v145, v135, -v147
    v_add_f32 v116, v108, v150
    v_add_f32 v117, v109, v151
    v_add_f32 v110, v108, -v150
    v_add_f32 v111, v109, -v151
    v_add_f32 v118, v114, v116
    v_add_f32 v119, v115, v117
    v_add_f32 v122, v114, -v116
    v_add_f32 v123, v115, -v117
    v_add_f32 v128, v144, -v111
    v_add_f32 v129, v145, v110
    v_add_f32 v126, v144, v111
    v_add_f32 v127, v145, -v110
    v_add_f32 v130, v132, -v139
    v_add_f32 v131, v133, v138
    v_add_f32 v124, v132, v139
    v_add_f32 v125, v133, -v138
    v_add_f32 v148, v104, v136
    v_add_f32 v149, v105, v137
    v_add_f32 v106, v104, -v136
    v_add_f32 v107, v105, -v137
    v_add_f32 v140, v130, v148
    v_add_f32 v141, v131, v149
    v_add_f32 v120, v130, -v148
    v_add_f32 v121, v131, -v149
    v_add_f32 v142, v124, -v107
    v_add_f32 v143, v125, v106
    v_add_f32 v112, v124, v107
    v_add_f32 v113, v125, -v106
    ds_write_b64 v6, v[118:119] offset:0
    ds_write_b64 v6, v[140:141] offset:32
    ds_write_b64 v6, v[128:129] offset:64
    ds_write_b64 v6, v[142:143] offset:96
    ds_write_b64 v6, v[122:123] offset:128
    ds_write_b64 v6, v[120:121] offset:160
    ds_write_b64 v6, v[126:127] offset:192
    ds_write_b64 v6, v[112:113] offset:224
    s_waitcnt lgkmcnt(0)
    s_barrier
    ds_read_b64 v[134:135], v5 offset:0
    ds_read_b64 v[146:147], v5 offset:2304
    ds_read_b64 v[108:109], v5 offset:4608
    ds_read_b64 v[150:151], v5 offset:6912
    ds_read_b64 v[114:115], v5 offset:9216
    ds_read_b64 v[116:117], v5 offset:11520
    ds_read_b64 v[144:145], v5 offset:13824
    ds_read_b64 v[110:111], v5 offset:16128
    s_waitcnt lgkmcnt(0)
    v_mul_f32 v132, v146, v54
    v_fma_f32 v132, v147, v55, v132
    v_mul_f32 v133, v147, v54
    v_fma_f32 v133, -v146, v55, v133
    v_mul_f32 v138, v108, v56
    v_fma_f32 v138, v109, v57, v138
    v_mul_f32 v139, v109, v56
    v_fma_f32 v139, -v108, v57, v139
    v_mul_f32 v104, v150, v58
    v_fma_f32 v104, v151, v59, v104
    v_mul_f32 v105, v151, v58
    v_fma_f32 v105, -v150, v59, v105
    v_mul_f32 v136, v114, v60
    v_fma_f32 v136, v115, v61, v136
    v_mul_f32 v137, v115, v60
    v_fma_f32 v137, -v114, v61, v137
    v_mul_f32 v130, v116, v62
    v_fma_f32 v130, v117, v63, v130
    v_mul_f32 v131, v117, v62
    v_fma_f32 v131, -v116, v63, v131
    v_mul_f32 v148, v144, v64
    v_fma_f32 v148, v145, v65, v148
    v_mul_f32 v149, v145, v64
    v_fma_f32 v149, -v144, v65, v149
    v_mul_f32 v124, v110, v66
    v_fma_f32 v124, v111, v67, v124
    v_mul_f32 v125, v111, v66
    v_fma_f32 v125, -v110, v67, v125
    v_add_f32 v106, v134, v136
    v_add_f32 v107, v135, v137
    v_add_f32 v118, v134, -v136
    v_add_f32 v119, v135, -v137
    v_add_f32 v140, v132, v130
    v_add_f32 v141, v133, v131
    v_add_f32 v128, v132, -v130
    v_add_f32 v129, v133, -v131
    v_add_f32 v142, v138, v148
    v_add_f32 v143, v139, v149
    v_add_f32 v122, v138, -v148
    v_add_f32 v123, v139, -v149
    v_add_f32 v120, v104, v124
    v_add_f32 v121, v105, v125
    v_add_f32 v126, v104, -v124
    v_add_f32 v127, v105, -v125
    v_add_f32 v112, v128, -v129
    v_add_f32 v113, v129, v128
    v_mul_f32 v112, s26, v112
    v_mul_f32 v113, s26, v113
    v_add_f32 v146, -v126, -v127
    v_add_f32 v147, -v127, v126
    v_mul_f32 v146, s26, v146
    v_mul_f32 v147, s26, v147
    v_add_f32 v108, v106, v142
    v_add_f32 v109, v107, v143
    v_add_f32 v150, v106, -v142
    v_add_f32 v151, v107, -v143
    v_add_f32 v114, v140, v120
    v_add_f32 v115, v141, v121
    v_add_f32 v116, v140, -v120
    v_add_f32 v117, v141, -v121
    v_add_f32 v144, v108, v114
    v_add_f32 v145, v109, v115
    v_add_f32 v110, v108, -v114
    v_add_f32 v111, v109, -v115
    v_add_f32 v134, v150, -v117
    v_add_f32 v135, v151, v116
    v_add_f32 v136, v150, v117
    v_add_f32 v137, v151, -v116
    v_add_f32 v132, v118, -v123
    v_add_f32 v133, v119, v122
    v_add_f32 v130, v118, v123
    v_add_f32 v131, v119, -v122
    v_add_f32 v138, v112, v146
    v_add_f32 v139, v113, v147
    v_add_f32 v148, v112, -v146
    v_add_f32 v149, v113, -v147
    v_add_f32 v104, v132, v138
    v_add_f32 v105, v133, v139
    v_add_f32 v124, v132, -v138
    v_add_f32 v125, v133, -v139
    v_add_f32 v128, v130, -v149
    v_add_f32 v129, v131, v148
    v_add_f32 v126, v130, v149
    v_add_f32 v127, v131, -v148
    ds_write_b64 v4, v[144:145] offset:18432
    ds_write_b64 v4, v[104:105] offset:18688
    ds_write_b64 v4, v[134:135] offset:18944
    ds_write_b64 v4, v[128:129] offset:19200
    ds_write_b64 v4, v[110:111] offset:19456
    ds_write_b64 v4, v[124:125] offset:19712
    ds_write_b64 v4, v[136:137] offset:19968
    ds_write_b64 v4, v[126:127] offset:20224
    s_waitcnt lgkmcnt(0)
    s_barrier
    ds_read_b64 v[106:107], v2 offset:18432
    ds_read_b64 v[142:143], v2 offset:20480
    ds_read_b64 v[140:141], v2 offset:22528
    ds_read_b64 v[120:121], v2 offset:24576
    ds_read_b64 v[108:109], v2 offset:26624
    ds_read_b64 v[114:115], v2 offset:28672
    ds_read_b64 v[150:151], v2 offset:30720
    ds_read_b64 v[116:117], v2 offset:32768
    s_waitcnt lgkmcnt(0)
    v_mul_f32 v118, v142, v40
    v_fma_f32 v118, v143, v41, v118
    v_mul_f32 v119, v143, v40
    v_fma_f32 v119, -v142, v41, v119
    v_mul_f32 v122, v140, v42
    v_fma_f32 v122, v141, v43, v122
    v_mul_f32 v123, v141, v42
    v_fma_f32 v123, -v140, v43, v123
    v_mul_f32 v112, v120, v44
    v_fma_f32 v112, v121, v45, v112
    v_mul_f32 v113, v121, v44
    v_fma_f32 v113, -v120, v45, v113
    v_mul_f32 v146, v108, v46
    v_fma_f32 v146, v109, v47, v146
    v_mul_f32 v147, v109, v46
    v_fma_f32 v147, -v108, v47, v147
    v_mul_f32 v132, v114, v48
    v_fma_f32 v132, v115, v49, v132
    v_mul_f32 v133, v115, v48
    v_fma_f32 v133, -v114, v49, v133
    v_mul_f32 v138, v150, v50
    v_fma_f32 v138, v151, v51, v138
    v_mul_f32 v139, v151, v50
    v_fma_f32 v139, -v150, v51, v139
    v_mul_f32 v130, v116, v52
    v_fma_f32 v130, v117, v53, v130
    v_mul_f32 v131, v117, v52
    v_fma_f32 v131, -v116, v53, v131
    v_add_f32 v148, v106, v146
    v_add_f32 v149, v107, v147
    v_add_f32 v144, v106, -v146
    v_add_f32 v145, v107, -v147
    v_add_f32 v104, v118, v132
    v_add_f32 v105, v119, v133
    v_add_f32 v134, v118, -v132
    v_add_f32 v135, v119, -v133
    v_add_f32 v128, v122, v138
    v_add_f32 v129, v123, v139
    v_add_f32 v110, v122, -v138
    v_add_f32 v111, v123, -v139
    v_add_f32 v124, v112, v130
    v_add_f32 v125, v113, v131
    v_add_f32 v136, v112, -v130
    v_add_f32 v137, v113, -v131
    v_add_f32 v126, v134, -v135
    v_add_f32 v127, v135, v134
    v_mul_f32 v126, s26, v126
    v_mul_f32 v127, s26, v127
    v_add_f32 v142, -v136, -v137
    v_add_f32 v143, -v137, v136
    v_mul_f32 v142, s26, v142
    v_mul_f32 v143, s26, v143
    v_add_f32 v140, v148, v128
    v_add_f32 v141, v149, v129
    v_add_f32 v120, v148, -v128
    v_add_f32 v121, v149, -v129
    v_add_f32 v108, v104, v124
    v_add_f32 v109, v105, v125
    v_add_f32 v114, v104, -v124
    v_add_f32 v115, v105, -v125
    v_add_f32 v150, v140, v108
    v_add_f32 v151, v141, v109
    v_add_f32 v116, v140, -v108
    v_add_f32 v117, v141, -v109
    v_add_f32 v106, v120, -v115
    v_add_f32 v107, v121, v114
    v_add_f32 v146, v120, v115
    v_add_f32 v147, v121, -v114
    v_add_f32 v118, v144, -v111
    v_add_f32 v119, v145, v110
    v_add_f32 v132, v144, v111
    v_add_f32 v133, v145, -v110
    v_add_f32 v122, v126, v142
    v_add_f32 v123, v127, v143
    v_add_f32 v138, v126, -v142
    v_add_f32 v139, v127, -v143
    v_add_f32 v112, v118, v122
    v_add_f32 v113, v119, v123
    v_add_f32 v130, v118, -v122
    v_add_f32 v131, v119, -v123
    v_add_f32 v134, v132, -v139
    v_add_f32 v135, v133, v138
    v_add_f32 v136, v132, v139
    v_add_f32 v137, v133, -v138
    buffer_store_dwordx2 v[150:151], v2, s[12:15], s40 offen
    buffer_store_dwordx2 v[112:113], v2, s[12:15], s41 offen
    buffer_store_dwordx2 v[106:107], v2, s[12:15], s42 offen
    buffer_store_dwordx2 v[134:135], v2, s[12:15], s43 offen
    buffer_store_dwordx2 v[116:117], v2, s[12:15], s44 offen
    buffer_store_dwordx2 v[130:131], v2, s[12:15], s45 offen
    buffer_store_dwordx2 v[146:147], v2, s[12:15], s46 offen
    buffer_store_dwordx2 v[136:137], v2, s[12:15], s47 offen
    s_endpgm
l2_end:
s_endpgm
.section .rodata,"a"
.p2align 6
.amdhsa_kernel l2_kernel
  .amdhsa_next_free_vgpr 240
  .amdhsa_next_free_sgpr 102
  .amdhsa_accum_offset 240
  .amdhsa_group_segment_fixed_size 0
  .amdhsa_kernarg_size 80
  .amdhsa_user_sgpr_count 2
  .amdhsa_user_sgpr_kernarg_segment_ptr 1
  .amdhsa_system_sgpr_workgroup_id_x 1
.end_amdhsa_kernel
.text
.globl l3_kernel
.p2align 8
.type l3_kernel,@function
l3_kernel:
    s_load_dwordx2 s[4:5], s[0:1], 0
    s_load_dwordx2 s[6:7], s[0:1], 72
    s_cmp_ge_u32 s2, 512
    s_cbranch_scc1 l3_end
    s_waitcnt lgkmcnt(0)
    s_cmp_lt_u32 s2, 256
    s_cbranch_scc1 l3_ke_start
    s_branch l3_kd_start
l3_ke_start:
    s_and_b32 s3, s2, 7
    s_lshl_b32 s3, s3, 5
    s_lshr_b32 s45, s2, 3
    s_add_u32 s3, s3, s45
    s_load_dwordx2 s[36:37], s[0:1], 64
    v_and_b32 v1, 63, v0
    v_lshrrev_b32 v2, 6, v0
    s_nop 0
    v_readfirstlane_b32 s8, v2
    s_lshl_b32 s9, s3, 2
    s_add_u32 s9, s9, s8
    s_mul_i32 s10, s8, 4608
    s_mov_b32 s12, s4
    s_mov_b32 s13, s5
    s_mov_b32 s14, 0x200000
    s_mov_b32 s15, 0x00020000
    s_add_u32 s16, s6, 0x3a00000
    s_addc_u32 s17, s7, 0
    s_mov_b32 s18, 0x200000
    s_mov_b32 s19, 0x00020000
    s_add_u32 s20, s6, 0x800000
    s_addc_u32 s21, s7, 0
    s_mov_b32 s22, 0x404000
    s_mov_b32 s23, 0x00020000
    s_lshl_b32 s11, s9, 11
    v_lshlrev_b32 v3, 4, v1
    v_lshlrev_b32 v86, 14, v1
    s_lshl_b32 s29, s9, 4
    s_add_u32 s32, s29, 0x0
    buffer_load_dwordx4 v[152:155], v86, s[20:23], s32 offen
    s_add_u32 s32, s29, 0x100000
    buffer_load_dwordx4 v[156:159], v86, s[20:23], s32 offen
    s_add_u32 s32, s29, 0x200000
    buffer_load_dwordx4 v[160:163], v86, s[20:23], s32 offen
    s_add_u32 s32, s29, 0x300000
    buffer_load_dwordx4 v[164:167], v86, s[20:23], s32 offen
    s_add_u32 s32, s29, 0x400000
    buffer_load_dwordx4 v[168:171], v86, s[20:23], s32 offen
    s_mov_b32 s26, 0x3f3504f3
    v_and_b32 v12, 511, v1
    v_cvt_f32_u32 v12, v12
    v_mul_f32 v12, 0xbb000000, v12
    v_cos_f32 v52, v12
    v_sin_f32 v53, v12
    v_mul_u32_u24 v12, 2, v1
    v_and_b32 v12, 511, v12
    v_cvt_f32_u32 v12, v12
    v_mul_f32 v12, 0xbb000000, v12
    v_cos_f32 v54, v12
    v_sin_f32 v55, v12
    v_mul_u32_u24 v12, 3, v1
    v_and_b32 v12, 511, v12
    v_cvt_f32_u32 v12, v12
    v_mul_f32 v12, 0xbb000000, v12
    v_cos_f32 v56, v12
    v_sin_f32 v57, v12
    v_mul_u32_u24 v12, 4, v1
    v_and_b32 v12, 511, v12
    v_cvt_f32_u32 v12, v12
    v_mul_f32 v12, 0xbb000000, v12
    v_cos_f32 v58, v12
    v_sin_f32 v59, v12
    v_mul_u32_u24 v12, 5, v1
    v_and_b32 v12, 511, v12
    v_cvt_f32_u32 v12, v12
    v_mul_f32 v12, 0xbb000000, v12
    v_cos_f32 v60, v12
    v_sin_f32 v61, v12
    v_mul_u32_u24 v12, 6, v1
    v_and_b32 v12, 511, v12
    v_cvt_f32_u32 v12, v12
    v_mul_f32 v12, 0xbb000000, v12
    v_cos_f32 v62, v12
    v_sin_f32 v63, v12
    v_mul_u32_u24 v12, 7, v1
    v_and_b32 v12, 511, v12
    v_cvt_f32_u32 v12, v12
    v_mul_f32 v12, 0xbb000000, v12
    v_cos_f32 v64, v12
    v_sin_f32 v65, v12
    s_nop 0
    v_and_b32 v13, 7, v1
    v_and_b32 v12, 63, v13
    v_cvt_f32_u32 v12, v12
    v_mul_f32 v12, 0xbc800000, v12
    v_cos_f32 v66, v12
    v_sin_f32 v67, v12
    v_mul_u32_u24 v12, 2, v13
    v_and_b32 v12, 63, v12
    v_cvt_f32_u32 v12, v12
    v_mul_f32 v12, 0xbc800000, v12
    v_cos_f32 v68, v12
    v_sin_f32 v69, v12
    v_mul_u32_u24 v12, 3, v13
    v_and_b32 v12, 63, v12
    v_cvt_f32_u32 v12, v12
    v_mul_f32 v12, 0xbc800000, v12
    v_cos_f32 v70, v12
    v_sin_f32 v71, v12
    v_mul_u32_u24 v12, 4, v13
    v_and_b32 v12, 63, v12
    v_cvt_f32_u32 v12, v12
    v_mul_f32 v12, 0xbc800000, v12
    v_cos_f32 v72, v12
    v_sin_f32 v73, v12
    v_mul_u32_u24 v12, 5, v13
    v_and_b32 v12, 63, v12
    v_cvt_f32_u32 v12, v12
    v_mul_f32 v12, 0xbc800000, v12
    v_cos_f32 v74, v12
    v_sin_f32 v75, v12
    v_mul_u32_u24 v12, 6, v13
    v_and_b32 v12, 63, v12
    v_cvt_f32_u32 v12, v12
    v_mul_f32 v12, 0xbc800000, v12
    v_cos_f32 v76, v12
    v_sin_f32 v77, v12
    v_mul_u32_u24 v12, 7, v13
    v_and_b32 v12, 63, v12
    v_cvt_f32_u32 v12, v12
    v_mul_f32 v12, 0xbc800000, v12
    v_cos_f32 v78, v12
    v_sin_f32 v79, v12
    s_nop 0
    v_mul_u32_u24 v14, 72, v1
    v_add_u32 v14, s10, v14
    v_lshrrev_b32 v12, 3, v1
    v_add_u32 v15, v12, v1
    v_lshlrev_b32 v15, 3, v15
    v_add_u32 v15, s10, v15
    v_lshlrev_b32 v80, 3, v1
    v_add_u32 v80, s10, v80
    v_mul_u32_u24 v81, 576, v12
    v_add_u32 v81, s10, v81
    v_lshlrev_b32 v82, 3, v13
    v_add_u32 v82, v81, v82
    v_lshlrev_b32 v83, 6, v13
    v_add_u32 v83, v81, v83
    v_sub_u32 v84, 256, v1
    v_lshlrev_b32 v84, 3, v84
    v_add_u32 v84, s10, v84
    s_waitcnt lgkmcnt(0)
    s_mov_b32 s40, s36
    s_mov_b32 s41, s37
    s_mov_b32 s42, 0x100
    s_mov_b32 s43, 0x00020000
    v_cmp_eq_u32 vcc, 0, v1
    s_waitcnt vmcnt(0)
    v_cndmask_b32 v153, v153, 0, vcc
    v_cndmask_b32 v155, v155, 0, vcc
    v_cndmask_b32 v169, v169, 0, vcc
    v_cndmask_b32 v171, v171, 0, vcc
    v_sub_f32 v104, v152, v155
    v_add_f32 v105, v153, v154
    v_add_f32 v106, v152, v155
    v_sub_f32 v107, v154, v153
    ds_write_b64 v84, v[106:107] offset:2048
    v_sub_f32 v108, v156, v159
    v_add_f32 v109, v157, v158
    v_add_f32 v110, v156, v159
    v_sub_f32 v111, v158, v157
    ds_write_b64 v84, v[110:111] offset:1536
    v_sub_f32 v112, v160, v163
    v_add_f32 v113, v161, v162
    v_add_f32 v114, v160, v163
    v_sub_f32 v115, v162, v161
    ds_write_b64 v84, v[114:115] offset:1024
    v_sub_f32 v116, v164, v167
    v_add_f32 v117, v165, v166
    v_add_f32 v118, v164, v167
    v_sub_f32 v119, v166, v165
    ds_write_b64 v84, v[118:119] offset:512
    v_sub_f32 v120, v168, v171
    v_add_f32 v121, v169, v170
    ds_write_b64 v84, v[120:121] offset:0
    ds_read_b64 v[122:123], v80 offset:2048
    ds_read_b64 v[124:125], v80 offset:2560
    ds_read_b64 v[126:127], v80 offset:3072
    ds_read_b64 v[128:129], v80 offset:3584
    s_waitcnt lgkmcnt(0)
    v_add_f32 v130, v104, v122
    v_add_f32 v131, v105, v123
    v_add_f32 v132, v104, -v122
    v_add_f32 v133, v105, -v123
    v_add_f32 v134, v108, v124
    v_add_f32 v135, v109, v125
    v_add_f32 v136, v108, -v124
    v_add_f32 v137, v109, -v125
    v_add_f32 v138, v112, v126
    v_add_f32 v139, v113, v127
    v_add_f32 v140, v112, -v126
    v_add_f32 v141, v113, -v127
    v_add_f32 v142, v116, v128
    v_add_f32 v143, v117, v129
    v_add_f32 v144, v116, -v128
    v_add_f32 v145, v117, -v129
    v_add_f32 v146, v136, -v137
    v_add_f32 v147, v137, v136
    v_mul_f32 v146, s26, v146
    v_mul_f32 v147, s26, v147
    v_add_f32 v148, -v144, -v145
    v_add_f32 v149, -v145, v144
    v_mul_f32 v148, s26, v148
    v_mul_f32 v149, s26, v149
    v_add_f32 v150, v130, v138
    v_add_f32 v151, v131, v139
    v_add_f32 v106, v130, -v138
    v_add_f32 v107, v131, -v139
    v_add_f32 v110, v134, v142
    v_add_f32 v111, v135, v143
    v_add_f32 v114, v134, -v142
    v_add_f32 v115, v135, -v143
    v_add_f32 v118, v150, v110
    v_add_f32 v119, v151, v111
    v_add_f32 v120, v150, -v110
    v_add_f32 v121, v151, -v111
    v_add_f32 v104, v106, -v115
    v_add_f32 v105, v107, v114
    v_add_f32 v122, v106, v115
    v_add_f32 v123, v107, -v114
    v_add_f32 v108, v132, -v141
    v_add_f32 v109, v133, v140
    v_add_f32 v124, v132, v141
    v_add_f32 v125, v133, -v140
    v_add_f32 v112, v146, v148
    v_add_f32 v113, v147, v149
    v_add_f32 v126, v146, -v148
    v_add_f32 v127, v147, -v149
    v_add_f32 v116, v108, v112
    v_add_f32 v117, v109, v113
    v_add_f32 v128, v108, -v112
    v_add_f32 v129, v109, -v113
    v_add_f32 v136, v124, -v127
    v_add_f32 v137, v125, v126
    v_add_f32 v144, v124, v127
    v_add_f32 v145, v125, -v126
    ds_write_b64 v83, v[118:119] offset:0
    ds_write_b64 v83, v[116:117] offset:8
    ds_write_b64 v83, v[104:105] offset:16
    ds_write_b64 v83, v[136:137] offset:24
    ds_write_b64 v83, v[120:121] offset:32
    ds_write_b64 v83, v[128:129] offset:40
    ds_write_b64 v83, v[122:123] offset:48
    ds_write_b64 v83, v[144:145] offset:56
    ds_read_b64 v[130:131], v80 offset:0
    ds_read_b64 v[138:139], v80 offset:576
    ds_read_b64 v[134:135], v80 offset:1152
    ds_read_b64 v[142:143], v80 offset:1728
    ds_read_b64 v[150:151], v80 offset:2304
    ds_read_b64 v[110:111], v80 offset:2880
    ds_read_b64 v[106:107], v80 offset:3456
    ds_read_b64 v[114:115], v80 offset:4032
    s_waitcnt lgkmcnt(0)
    v_mul_f32 v132, v138, v66
    v_fma_f32 v132, v139, v67, v132
    v_mul_f32 v133, v139, v66
    v_fma_f32 v133, -v138, v67, v133
    v_mul_f32 v140, v134, v68
    v_fma_f32 v140, v135, v69, v140
    v_mul_f32 v141, v135, v68
    v_fma_f32 v141, -v134, v69, v141
    v_mul_f32 v146, v142, v70
    v_fma_f32 v146, v143, v71, v146
    v_mul_f32 v147, v143, v70
    v_fma_f32 v147, -v142, v71, v147
    v_mul_f32 v148, v150, v72
    v_fma_f32 v148, v151, v73, v148
    v_mul_f32 v149, v151, v72
    v_fma_f32 v149, -v150, v73, v149
    v_mul_f32 v108, v110, v74
    v_fma_f32 v108, v111, v75, v108
    v_mul_f32 v109, v111, v74
    v_fma_f32 v109, -v110, v75, v109
    v_mul_f32 v112, v106, v76
    v_fma_f32 v112, v107, v77, v112
    v_mul_f32 v113, v107, v76
    v_fma_f32 v113, -v106, v77, v113
    v_mul_f32 v124, v114, v78
    v_fma_f32 v124, v115, v79, v124
    v_mul_f32 v125, v115, v78
    v_fma_f32 v125, -v114, v79, v125
    v_add_f32 v126, v130, v148
    v_add_f32 v127, v131, v149
    v_add_f32 v118, v130, -v148
    v_add_f32 v119, v131, -v149
    v_add_f32 v116, v132, v108
    v_add_f32 v117, v133, v109
    v_add_f32 v104, v132, -v108
    v_add_f32 v105, v133, -v109
    v_add_f32 v136, v140, v112
    v_add_f32 v137, v141, v113
    v_add_f32 v120, v140, -v112
    v_add_f32 v121, v141, -v113
    v_add_f32 v128, v146, v124
    v_add_f32 v129, v147, v125
    v_add_f32 v122, v146, -v124
    v_add_f32 v123, v147, -v125
    v_add_f32 v144, v104, -v105
    v_add_f32 v145, v105, v104
    v_mul_f32 v144, s26, v144
    v_mul_f32 v145, s26, v145
    v_add_f32 v138, -v122, -v123
    v_add_f32 v139, -v123, v122
    v_mul_f32 v138, s26, v138
    v_mul_f32 v139, s26, v139
    v_add_f32 v134, v126, v136
    v_add_f32 v135, v127, v137
    v_add_f32 v142, v126, -v136
    v_add_f32 v143, v127, -v137
    v_add_f32 v150, v116, v128
    v_add_f32 v151, v117, v129
    v_add_f32 v110, v116, -v128
    v_add_f32 v111, v117, -v129
    v_add_f32 v106, v134, v150
    v_add_f32 v107, v135, v151
    v_add_f32 v114, v134, -v150
    v_add_f32 v115, v135, -v151
    v_add_f32 v130, v142, -v111
    v_add_f32 v131, v143, v110
    v_add_f32 v148, v142, v111
    v_add_f32 v149, v143, -v110
    v_add_f32 v132, v118, -v121
    v_add_f32 v133, v119, v120
    v_add_f32 v108, v118, v121
    v_add_f32 v109, v119, -v120
    v_add_f32 v140, v144, v138
    v_add_f32 v141, v145, v139
    v_add_f32 v112, v144, -v138
    v_add_f32 v113, v145, -v139
    v_add_f32 v146, v132, v140
    v_add_f32 v147, v133, v141
    v_add_f32 v124, v132, -v140
    v_add_f32 v125, v133, -v141
    v_add_f32 v104, v108, -v113
    v_add_f32 v105, v109, v112
    v_add_f32 v122, v108, v113
    v_add_f32 v123, v109, -v112
    ds_write_b64 v82, v[106:107] offset:0
    ds_write_b64 v82, v[146:147] offset:64
    ds_write_b64 v82, v[130:131] offset:128
    ds_write_b64 v82, v[104:105] offset:192
    ds_write_b64 v82, v[114:115] offset:256
    ds_write_b64 v82, v[124:125] offset:320
    ds_write_b64 v82, v[148:149] offset:384
    ds_write_b64 v82, v[122:123] offset:448
    ds_read_b64 v[126:127], v80 offset:0
    ds_read_b64 v[136:137], v80 offset:576
    ds_read_b64 v[116:117], v80 offset:1152
    ds_read_b64 v[128:129], v80 offset:1728
    ds_read_b64 v[134:135], v80 offset:2304
    ds_read_b64 v[150:151], v80 offset:2880
    ds_read_b64 v[142:143], v80 offset:3456
    ds_read_b64 v[110:111], v80 offset:4032
    s_waitcnt lgkmcnt(0)
    v_mul_f32 v118, v136, v52
    v_fma_f32 v118, v137, v53, v118
    v_mul_f32 v119, v137, v52
    v_fma_f32 v119, -v136, v53, v119
    v_mul_f32 v120, v116, v54
    v_fma_f32 v120, v117, v55, v120
    v_mul_f32 v121, v117, v54
    v_fma_f32 v121, -v116, v55, v121
    v_mul_f32 v144, v128, v56
    v_fma_f32 v144, v129, v57, v144
    v_mul_f32 v145, v129, v56
    v_fma_f32 v145, -v128, v57, v145
    v_mul_f32 v138, v134, v58
    v_fma_f32 v138, v135, v59, v138
    v_mul_f32 v139, v135, v58
    v_fma_f32 v139, -v134, v59, v139
    v_mul_f32 v132, v150, v60
    v_fma_f32 v132, v151, v61, v132
    v_mul_f32 v133, v151, v60
    v_fma_f32 v133, -v150, v61, v133
    v_mul_f32 v140, v142, v62
    v_fma_f32 v140, v143, v63, v140
    v_mul_f32 v141, v143, v62
    v_fma_f32 v141, -v142, v63, v141
    v_mul_f32 v108, v110, v64
    v_fma_f32 v108, v111, v65, v108
    v_mul_f32 v109, v111, v64
    v_fma_f32 v109, -v110, v65, v109
    v_add_f32 v112, v126, v138
    v_add_f32 v113, v127, v139
    v_add_f32 v106, v126, -v138
    v_add_f32 v107, v127, -v139
    v_add_f32 v146, v118, v132
    v_add_f32 v147, v119, v133
    v_add_f32 v130, v118, -v132
    v_add_f32 v131, v119, -v133
    v_add_f32 v104, v120, v140
    v_add_f32 v105, v121, v141
    v_add_f32 v114, v120, -v140
    v_add_f32 v115, v121, -v141
    v_add_f32 v124, v144, v108
    v_add_f32 v125, v145, v109
    v_add_f32 v148, v144, -v108
    v_add_f32 v149, v145, -v109
    v_add_f32 v122, v130, -v131
    v_add_f32 v123, v131, v130
    v_mul_f32 v122, s26, v122
    v_mul_f32 v123, s26, v123
    v_add_f32 v136, -v148, -v149
    v_add_f32 v137, -v149, v148
    v_mul_f32 v136, s26, v136
    v_mul_f32 v137, s26, v137
    v_add_f32 v116, v112, v104
    v_add_f32 v117, v113, v105
    v_add_f32 v128, v112, -v104
    v_add_f32 v129, v113, -v105
    v_add_f32 v134, v146, v124
    v_add_f32 v135, v147, v125
    v_add_f32 v150, v146, -v124
    v_add_f32 v151, v147, -v125
    v_add_f32 v142, v116, v134
    v_add_f32 v143, v117, v135
    v_add_f32 v110, v116, -v134
    v_add_f32 v111, v117, -v135
    v_add_f32 v126, v128, -v151
    v_add_f32 v127, v129, v150
    v_add_f32 v138, v128, v151
    v_add_f32 v139, v129, -v150
    v_add_f32 v118, v106, -v115
    v_add_f32 v119, v107, v114
    v_add_f32 v132, v106, v115
    v_add_f32 v133, v107, -v114
    v_add_f32 v120, v122, v136
    v_add_f32 v121, v123, v137
    v_add_f32 v140, v122, -v136
    v_add_f32 v141, v123, -v137
    v_add_f32 v144, v118, v120
    v_add_f32 v145, v119, v121
    v_add_f32 v108, v118, -v120
    v_add_f32 v109, v119, -v121
    v_add_f32 v130, v132, -v141
    v_add_f32 v131, v133, v140
    v_add_f32 v148, v132, v141
    v_add_f32 v149, v133, -v140
    ds_write_b64 v15, v[142:143] offset:0
    ds_write_b64 v15, v[144:145] offset:576
    ds_write_b64 v15, v[126:127] offset:1152
    ds_write_b64 v15, v[130:131] offset:1728
    ds_write_b64 v15, v[110:111] offset:2304
    ds_write_b64 v15, v[108:109] offset:2880
    ds_write_b64 v15, v[138:139] offset:3456
    ds_write_b64 v15, v[148:149] offset:4032
    ds_read_b64 v[16:17], v14 offset:0
    ds_read_b64 v[18:19], v14 offset:8
    ds_read_b64 v[20:21], v14 offset:16
    ds_read_b64 v[22:23], v14 offset:24
    ds_read_b64 v[24:25], v14 offset:32
    ds_read_b64 v[26:27], v14 offset:40
    ds_read_b64 v[28:29], v14 offset:48
    ds_read_b64 v[30:31], v14 offset:56
    v_mov_b32 v87, 0x35000000
    s_waitcnt vmcnt(0) lgkmcnt(0)
    v_mul_f32 v12, v87, v16
    v_mul_f32 v13, v87, v18
    v_cvt_pk_bf16_f32 v96, v12, v13
    v_mul_f32 v12, v87, v20
    v_mul_f32 v13, v87, v22
    v_cvt_pk_bf16_f32 v97, v12, v13
    v_mul_f32 v12, v87, v24
    v_mul_f32 v13, v87, v26
    v_cvt_pk_bf16_f32 v98, v12, v13
    v_mul_f32 v12, v87, v28
    v_mul_f32 v13, v87, v30
    v_cvt_pk_bf16_f32 v99, v12, v13
    v_mul_f32 v12, v87, v17
    v_mul_f32 v13, v87, v19
    v_cvt_pk_bf16_f32 v100, v12, v13
    v_mul_f32 v12, v87, v21
    v_mul_f32 v13, v87, v23
    v_cvt_pk_bf16_f32 v101, v12, v13
    v_mul_f32 v12, v87, v25
    v_mul_f32 v13, v87, v27
    v_cvt_pk_bf16_f32 v102, v12, v13
    v_mul_f32 v12, v87, v29
    v_mul_f32 v13, v87, v31
    v_cvt_pk_bf16_f32 v103, v12, v13
    buffer_store_dwordx4 v[96:99], v3, s[16:19], s11 offen sc1
    buffer_store_dwordx4 v[100:103], v3, s[16:19], s11 offen offset:1024 sc1
    s_waitcnt vmcnt(0)
    s_barrier
    s_cmp_lg_u32 s8, 0
    s_cbranch_scc1 ke_sig_done
    s_lshr_b32 s28, s3, 3
    s_lshl_b32 s28, s28, 2
    v_mov_b32 v12, 1
    v_lshlrev_b32 v13, 2, v1
    v_cmp_eq_u32 vcc, 0, v1
    s_and_saveexec_b64 s[30:31], vcc
    buffer_atomic_add v12, v13, s[40:43], s28 offen sc1
    s_waitcnt vmcnt(0)
ke_sig_done:
    s_endpgm
l3_kd_start:
    s_sub_u32 s2, s2, 256
    s_mov_b32 s3, s2
    v_and_b32 v1, 63, v0
    v_lshrrev_b32 v2, 6, v0
    s_nop 0
    v_readfirstlane_b32 s8, v2
    s_and_b32 s9, s3, 31
    s_lshr_b32 s10, s3, 5
    s_add_u32 s12, s6, 0x2800000
    s_addc_u32 s13, s7, 0
    s_mov_b32 s14, 0x700000
    s_mov_b32 s15, 0x00020000
    s_add_u32 s16, s6, 0x2000000
    s_addc_u32 s17, s7, 0
    s_mov_b32 s18, 0x1c0000
    s_mov_b32 s19, 0x00020000
    s_load_dwordx2 s[36:37], s[0:1], 56
    s_load_dwordx2 s[38:39], s[0:1], 64
    s_waitcnt lgkmcnt(0)
    s_mov_b32 s20, s36
    s_mov_b32 s21, s37
    s_mov_b32 s22, 0x200000
    s_mov_b32 s23, 0x00020000
    s_mov_b32 s40, s38
    s_mov_b32 s41, s39
    s_mov_b32 s42, 0x100
    s_mov_b32 s43, 0x00020000
    s_mov_b32 s48, s4
    s_mov_b32 s49, s5
    s_mov_b32 s50, 0x200000
    s_mov_b32 s51, 0x00020000
    s_add_u32 s52, s6, 0x3a00000
    s_addc_u32 s53, s7, 0
    s_mov_b32 s54, 0x200000
    s_mov_b32 s55, 0x00020000
    s_mul_i32 s26, s8, 28
    s_lshl_b32 s24, s9, 1
    s_mul_i32 s24, s24, 112
    s_add_u32 s24, s24, s26
    s_lshl_b32 s24, s24, 10
    s_add_u32 s25, s24, 114688
    s_mul_i32 s27, s10, 112
    s_add_u32 s27, s27, s26
    s_lshl_b32 s27, s27, 11
    s_mov_b32 s44, 0xbfb8aa3b
    v_lshlrev_b32 v2, 4, v1
    s_add_u32 s30, s24, 0
    s_add_u32 s31, s25, 0
    s_add_u32 s32, s27, 0
    buffer_load_dwordx4 v[80:83], v2, s[16:19], s32 offen offset:0
    buffer_load_dwordx4 v[88:91], v2, s[12:15], s30 offen offset:0
    buffer_load_dwordx4 v[84:87], v2, s[16:19], s32 offen offset:1024
    buffer_load_dwordx4 v[92:95], v2, s[12:15], s31 offen offset:0
    buffer_load_dwordx4 v[96:99], v2, s[16:19], s32 offen offset:2048
    buffer_load_dwordx4 v[104:107], v2, s[12:15], s30 offen offset:1024
    buffer_load_dwordx4 v[100:103], v2, s[16:19], s32 offen offset:3072
    buffer_load_dwordx4 v[108:111], v2, s[12:15], s31 offen offset:1024
    s_add_u32 s32, s27, 4096
    buffer_load_dwordx4 v[112:115], v2, s[16:19], s32 offen offset:0
    buffer_load_dwordx4 v[120:123], v2, s[12:15], s30 offen offset:2048
    buffer_load_dwordx4 v[116:119], v2, s[16:19], s32 offen offset:1024
    buffer_load_dwordx4 v[124:127], v2, s[12:15], s31 offen offset:2048
    buffer_load_dwordx4 v[128:131], v2, s[16:19], s32 offen offset:2048
    buffer_load_dwordx4 v[136:139], v2, s[12:15], s30 offen offset:3072
    buffer_load_dwordx4 v[132:135], v2, s[16:19], s32 offen offset:3072
    buffer_load_dwordx4 v[140:143], v2, s[12:15], s31 offen offset:3072
    s_add_u32 s30, s24, 4096
    s_add_u32 s31, s25, 4096
    s_add_u32 s32, s27, 8192
    buffer_load_dwordx4 v[144:147], v2, s[16:19], s32 offen offset:0
    buffer_load_dwordx4 v[152:155], v2, s[12:15], s30 offen offset:0
    buffer_load_dwordx4 v[148:151], v2, s[16:19], s32 offen offset:1024
    buffer_load_dwordx4 v[156:159], v2, s[12:15], s31 offen offset:0
    buffer_load_dwordx4 v[160:163], v2, s[16:19], s32 offen offset:2048
    buffer_load_dwordx4 v[168:171], v2, s[12:15], s30 offen offset:1024
    buffer_load_dwordx4 v[164:167], v2, s[16:19], s32 offen offset:3072
    buffer_load_dwordx4 v[172:175], v2, s[12:15], s31 offen offset:1024
    s_add_u32 s32, s27, 12288
    buffer_load_dwordx4 v[176:179], v2, s[16:19], s32 offen offset:0
    buffer_load_dwordx4 v[184:187], v2, s[12:15], s30 offen offset:2048
    buffer_load_dwordx4 v[180:183], v2, s[16:19], s32 offen offset:1024
    buffer_load_dwordx4 v[188:191], v2, s[12:15], s31 offen offset:2048
    buffer_load_dwordx4 v[192:195], v2, s[16:19], s32 offen offset:2048
    buffer_load_dwordx4 v[200:203], v2, s[12:15], s30 offen offset:3072
    buffer_load_dwordx4 v[196:199], v2, s[16:19], s32 offen offset:3072
    buffer_load_dwordx4 v[204:207], v2, s[12:15], s31 offen offset:3072
    s_waitcnt vmcnt(30)
    v_mfma_f32_32x32x16_bf16 v[16:31], v[80:83], v[88:91], 0
    s_waitcnt vmcnt(29)
    v_mfma_f32_32x32x16_bf16 v[48:63], v[84:87], v[88:91], 0
    s_waitcnt vmcnt(28)
    v_mfma_f32_32x32x16_bf16 v[32:47], v[80:83], v[92:95], 0
    v_mfma_f32_32x32x16_bf16 v[64:79], v[84:87], v[92:95], 0
    s_add_u32 s30, s24, 8192
    s_add_u32 s31, s25, 8192
    s_add_u32 s32, s27, 16384
    buffer_load_dwordx4 v[80:83], v2, s[16:19], s32 offen offset:0
    buffer_load_dwordx4 v[88:91], v2, s[12:15], s30 offen offset:0
    buffer_load_dwordx4 v[84:87], v2, s[16:19], s32 offen offset:1024
    buffer_load_dwordx4 v[92:95], v2, s[12:15], s31 offen offset:0
    s_waitcnt vmcnt(30)
    v_mfma_f32_32x32x16_bf16 v[16:31], v[96:99], v[104:107], v[16:31]
    s_waitcnt vmcnt(29)
    v_mfma_f32_32x32x16_bf16 v[48:63], v[100:103], v[104:107], v[48:63]
    s_waitcnt vmcnt(28)
    v_mfma_f32_32x32x16_bf16 v[32:47], v[96:99], v[108:111], v[32:47]
    v_mfma_f32_32x32x16_bf16 v[64:79], v[100:103], v[108:111], v[64:79]
    buffer_load_dwordx4 v[96:99], v2, s[16:19], s32 offen offset:2048
    buffer_load_dwordx4 v[104:107], v2, s[12:15], s30 offen offset:1024
    buffer_load_dwordx4 v[100:103], v2, s[16:19], s32 offen offset:3072
    buffer_load_dwordx4 v[108:111], v2, s[12:15], s31 offen offset:1024
    s_waitcnt vmcnt(30)
    v_mfma_f32_32x32x16_bf16 v[16:31], v[112:115], v[120:123], v[16:31]
    s_waitcnt vmcnt(29)
    v_mfma_f32_32x32x16_bf16 v[48:63], v[116:119], v[120:123], v[48:63]
    s_waitcnt vmcnt(28)
    v_mfma_f32_32x32x16_bf16 v[32:47], v[112:115], v[124:127], v[32:47]
    v_mfma_f32_32x32x16_bf16 v[64:79], v[116:119], v[124:127], v[64:79]
    s_add_u32 s32, s27, 20480
    buffer_load_dwordx4 v[112:115], v2, s[16:19], s32 offen offset:0
    buffer_load_dwordx4 v[120:123], v2, s[12:15], s30 offen offset:2048
    buffer_load_dwordx4 v[116:119], v2, s[16:19], s32 offen offset:1024
    buffer_load_dwordx4 v[124:127], v2, s[12:15], s31 offen offset:2048
    s_waitcnt vmcnt(30)
    v_mfma_f32_32x32x16_bf16 v[16:31], v[128:131], v[136:139], v[16:31]
    s_waitcnt vmcnt(29)
    v_mfma_f32_32x32x16_bf16 v[48:63], v[132:135], v[136:139], v[48:63]
    s_waitcnt vmcnt(28)
    v_mfma_f32_32x32x16_bf16 v[32:47], v[128:131], v[140:143], v[32:47]
    v_mfma_f32_32x32x16_bf16 v[64:79], v[132:135], v[140:143], v[64:79]
    buffer_load_dwordx4 v[128:131], v2, s[16:19], s32 offen offset:2048
    buffer_load_dwordx4 v[136:139], v2, s[12:15], s30 offen offset:3072
    buffer_load_dwordx4 v[132:135], v2, s[16:19], s32 offen offset:3072
    buffer_load_dwordx4 v[140:143], v2, s[12:15], s31 offen offset:3072
    s_waitcnt vmcnt(30)
    v_mfma_f32_32x32x16_bf16 v[16:31], v[144:147], v[152:155], v[16:31]
    s_waitcnt vmcnt(29)
    v_mfma_f32_32x32x16_bf16 v[48:63], v[148:151], v[152:155], v[48:63]
    s_waitcnt vmcnt(28)
    v_mfma_f32_32x32x16_bf16 v[32:47], v[144:147], v[156:159], v[32:47]
    v_mfma_f32_32x32x16_bf16 v[64:79], v[148:151], v[156:159], v[64:79]
    s_add_u32 s30, s24, 12288
    s_add_u32 s31, s25, 12288
    s_add_u32 s32, s27, 24576
    buffer_load_dwordx4 v[144:147], v2, s[16:19], s32 offen offset:0
    buffer_load_dwordx4 v[152:155], v2, s[12:15], s30 offen offset:0
    buffer_load_dwordx4 v[148:151], v2, s[16:19], s32 offen offset:1024
    buffer_load_dwordx4 v[156:159], v2, s[12:15], s31 offen offset:0
    s_waitcnt vmcnt(30)
    v_mfma_f32_32x32x16_bf16 v[16:31], v[160:163], v[168:171], v[16:31]
    s_waitcnt vmcnt(29)
    v_mfma_f32_32x32x16_bf16 v[48:63], v[164:167], v[168:171], v[48:63]
    s_waitcnt vmcnt(28)
    v_mfma_f32_32x32x16_bf16 v[32:47], v[160:163], v[172:175], v[32:47]
    v_mfma_f32_32x32x16_bf16 v[64:79], v[164:167], v[172:175], v[64:79]
    buffer_load_dwordx4 v[160:163], v2, s[16:19], s32 offen offset:2048
    buffer_load_dwordx4 v[168:171], v2, s[12:15], s30 offen offset:1024
    buffer_load_dwordx4 v[164:167], v2, s[16:19], s32 offen offset:3072
    buffer_load_dwordx4 v[172:175], v2, s[12:15], s31 offen offset:1024
    s_waitcnt vmcnt(30)
    v_mfma_f32_32x32x16_bf16 v[16:31], v[176:179], v[184:187], v[16:31]
    s_waitcnt vmcnt(29)
    v_mfma_f32_32x32x16_bf16 v[48:63], v[180:183], v[184:187], v[48:63]
    s_waitcnt vmcnt(28)
    v_mfma_f32_32x32x16_bf16 v[32:47], v[176:179], v[188:191], v[32:47]
    v_mfma_f32_32x32x16_bf16 v[64:79], v[180:183], v[188:191], v[64:79]
    s_add_u32 s32, s27, 28672
    buffer_load_dwordx4 v[176:179], v2, s[16:19], s32 offen offset:0
    buffer_load_dwordx4 v[184:187], v2, s[12:15], s30 offen offset:2048
    buffer_load_dwordx4 v[180:183], v2, s[16:19], s32 offen offset:1024
    buffer_load_dwordx4 v[188:191], v2, s[12:15], s31 offen offset:2048
    s_waitcnt vmcnt(30)
    v_mfma_f32_32x32x16_bf16 v[16:31], v[192:195], v[200:203], v[16:31]
    s_waitcnt vmcnt(29)
    v_mfma_f32_32x32x16_bf16 v[48:63], v[196:199], v[200:203], v[48:63]
    s_waitcnt vmcnt(28)
    v_mfma_f32_32x32x16_bf16 v[32:47], v[192:195], v[204:207], v[32:47]
    v_mfma_f32_32x32x16_bf16 v[64:79], v[196:199], v[204:207], v[64:79]
    buffer_load_dwordx4 v[192:195], v2, s[16:19], s32 offen offset:2048
    buffer_load_dwordx4 v[200:203], v2, s[12:15], s30 offen offset:3072
    buffer_load_dwordx4 v[196:199], v2, s[16:19], s32 offen offset:3072
    buffer_load_dwordx4 v[204:207], v2, s[12:15], s31 offen offset:3072
    s_waitcnt vmcnt(30)
    v_mfma_f32_32x32x16_bf16 v[16:31], v[80:83], v[88:91], v[16:31]
    s_waitcnt vmcnt(29)
    v_mfma_f32_32x32x16_bf16 v[48:63], v[84:87], v[88:91], v[48:63]
    s_waitcnt vmcnt(28)
    v_mfma_f32_32x32x16_bf16 v[32:47], v[80:83], v[92:95], v[32:47]
    v_mfma_f32_32x32x16_bf16 v[64:79], v[84:87], v[92:95], v[64:79]
    s_add_u32 s30, s24, 16384
    s_add_u32 s31, s25, 16384
    s_add_u32 s32, s27, 32768
    buffer_load_dwordx4 v[80:83], v2, s[16:19], s32 offen offset:0
    buffer_load_dwordx4 v[88:91], v2, s[12:15], s30 offen offset:0
    buffer_load_dwordx4 v[84:87], v2, s[16:19], s32 offen offset:1024
    buffer_load_dwordx4 v[92:95], v2, s[12:15], s31 offen offset:0
    s_waitcnt vmcnt(30)
    v_mfma_f32_32x32x16_bf16 v[16:31], v[96:99], v[104:107], v[16:31]
    s_waitcnt vmcnt(29)
    v_mfma_f32_32x32x16_bf16 v[48:63], v[100:103], v[104:107], v[48:63]
    s_waitcnt vmcnt(28)
    v_mfma_f32_32x32x16_bf16 v[32:47], v[96:99], v[108:111], v[32:47]
    v_mfma_f32_32x32x16_bf16 v[64:79], v[100:103], v[108:111], v[64:79]
    buffer_load_dwordx4 v[96:99], v2, s[16:19], s32 offen offset:2048
    buffer_load_dwordx4 v[104:107], v2, s[12:15], s30 offen offset:1024
    buffer_load_dwordx4 v[100:103], v2, s[16:19], s32 offen offset:3072
    buffer_load_dwordx4 v[108:111], v2, s[12:15], s31 offen offset:1024
    s_waitcnt vmcnt(30)
    v_mfma_f32_32x32x16_bf16 v[16:31], v[112:115], v[120:123], v[16:31]
    s_waitcnt vmcnt(29)
    v_mfma_f32_32x32x16_bf16 v[48:63], v[116:119], v[120:123], v[48:63]
    s_waitcnt vmcnt(28)
    v_mfma_f32_32x32x16_bf16 v[32:47], v[112:115], v[124:127], v[32:47]
    v_mfma_f32_32x32x16_bf16 v[64:79], v[116:119], v[124:127], v[64:79]
    s_add_u32 s32, s27, 36864
    buffer_load_dwordx4 v[112:115], v2, s[16:19], s32 offen offset:0
    buffer_load_dwordx4 v[120:123], v2, s[12:15], s30 offen offset:2048
    buffer_load_dwordx4 v[116:119], v2, s[16:19], s32 offen offset:1024
    buffer_load_dwordx4 v[124:127], v2, s[12:15], s31 offen offset:2048
    s_waitcnt vmcnt(30)
    v_mfma_f32_32x32x16_bf16 v[16:31], v[128:131], v[136:139], v[16:31]
    s_waitcnt vmcnt(29)
    v_mfma_f32_32x32x16_bf16 v[48:63], v[132:135], v[136:139], v[48:63]
    s_waitcnt vmcnt(28)
    v_mfma_f32_32x32x16_bf16 v[32:47], v[128:131], v[140:143], v[32:47]
    v_mfma_f32_32x32x16_bf16 v[64:79], v[132:135], v[140:143], v[64:79]
    buffer_load_dwordx4 v[128:131], v2, s[16:19], s32 offen offset:2048
    buffer_load_dwordx4 v[136:139], v2, s[12:15], s30 offen offset:3072
    buffer_load_dwordx4 v[132:135], v2, s[16:19], s32 offen offset:3072
    buffer_load_dwordx4 v[140:143], v2, s[12:15], s31 offen offset:3072
    s_waitcnt vmcnt(30)
    v_mfma_f32_32x32x16_bf16 v[16:31], v[144:147], v[152:155], v[16:31]
    s_waitcnt vmcnt(29)
    v_mfma_f32_32x32x16_bf16 v[48:63], v[148:151], v[152:155], v[48:63]
    s_waitcnt vmcnt(28)
    v_mfma_f32_32x32x16_bf16 v[32:47], v[144:147], v[156:159], v[32:47]
    v_mfma_f32_32x32x16_bf16 v[64:79], v[148:151], v[156:159], v[64:79]
    s_add_u32 s30, s24, 20480
    s_add_u32 s31, s25, 20480
    s_add_u32 s32, s27, 40960
    buffer_load_dwordx4 v[144:147], v2, s[16:19], s32 offen offset:0
    buffer_load_dwordx4 v[152:155], v2, s[12:15], s30 offen offset:0
    buffer_load_dwordx4 v[148:151], v2, s[16:19], s32 offen offset:1024
    buffer_load_dwordx4 v[156:159], v2, s[12:15], s31 offen offset:0
    s_waitcnt vmcnt(30)
    v_mfma_f32_32x32x16_bf16 v[16:31], v[160:163], v[168:171], v[16:31]
    s_waitcnt vmcnt(29)
    v_mfma_f32_32x32x16_bf16 v[48:63], v[164:167], v[168:171], v[48:63]
    s_waitcnt vmcnt(28)
    v_mfma_f32_32x32x16_bf16 v[32:47], v[160:163], v[172:175], v[32:47]
    v_mfma_f32_32x32x16_bf16 v[64:79], v[164:167], v[172:175], v[64:79]
    buffer_load_dwordx4 v[160:163], v2, s[16:19], s32 offen offset:2048
    buffer_load_dwordx4 v[168:171], v2, s[12:15], s30 offen offset:1024
    buffer_load_dwordx4 v[164:167], v2, s[16:19], s32 offen offset:3072
    buffer_load_dwordx4 v[172:175], v2, s[12:15], s31 offen offset:1024
    s_waitcnt vmcnt(30)
    v_mfma_f32_32x32x16_bf16 v[16:31], v[176:179], v[184:187], v[16:31]
    s_waitcnt vmcnt(29)
    v_mfma_f32_32x32x16_bf16 v[48:63], v[180:183], v[184:187], v[48:63]
    s_waitcnt vmcnt(28)
    v_mfma_f32_32x32x16_bf16 v[32:47], v[176:179], v[188:191], v[32:47]
    v_mfma_f32_32x32x16_bf16 v[64:79], v[180:183], v[188:191], v[64:79]
    s_add_u32 s32, s27, 45056
    buffer_load_dwordx4 v[176:179], v2, s[16:19], s32 offen offset:0
    buffer_load_dwordx4 v[184:187], v2, s[12:15], s30 offen offset:2048
    buffer_load_dwordx4 v[180:183], v2, s[16:19], s32 offen offset:1024
    buffer_load_dwordx4 v[188:191], v2, s[12:15], s31 offen offset:2048
    s_waitcnt vmcnt(30)
    v_mfma_f32_32x32x16_bf16 v[16:31], v[192:195], v[200:203], v[16:31]
    s_waitcnt vmcnt(29)
    v_mfma_f32_32x32x16_bf16 v[48:63], v[196:199], v[200:203], v[48:63]
    s_waitcnt vmcnt(28)
    v_mfma_f32_32x32x16_bf16 v[32:47], v[192:195], v[204:207], v[32:47]
    v_mfma_f32_32x32x16_bf16 v[64:79], v[196:199], v[204:207], v[64:79]
    buffer_load_dwordx4 v[192:195], v2, s[16:19], s32 offen offset:2048
    buffer_load_dwordx4 v[200:203], v2, s[12:15], s30 offen offset:3072
    buffer_load_dwordx4 v[196:199], v2, s[16:19], s32 offen offset:3072
    buffer_load_dwordx4 v[204:207], v2, s[12:15], s31 offen offset:3072
    s_waitcnt vmcnt(30)
    v_mfma_f32_32x32x16_bf16 v[16:31], v[80:83], v[88:91], v[16:31]
    s_waitcnt vmcnt(29)
    v_mfma_f32_32x32x16_bf16 v[48:63], v[84:87], v[88:91], v[48:63]
    s_waitcnt vmcnt(28)
    v_mfma_f32_32x32x16_bf16 v[32:47], v[80:83], v[92:95], v[32:47]
    v_mfma_f32_32x32x16_bf16 v[64:79], v[84:87], v[92:95], v[64:79]
    s_add_u32 s30, s24, 24576
    s_add_u32 s31, s25, 24576
    s_add_u32 s32, s27, 49152
    buffer_load_dwordx4 v[80:83], v2, s[16:19], s32 offen offset:0
    buffer_load_dwordx4 v[88:91], v2, s[12:15], s30 offen offset:0
    buffer_load_dwordx4 v[84:87], v2, s[16:19], s32 offen offset:1024
    buffer_load_dwordx4 v[92:95], v2, s[12:15], s31 offen offset:0
    s_waitcnt vmcnt(30)
    v_mfma_f32_32x32x16_bf16 v[16:31], v[96:99], v[104:107], v[16:31]
    s_waitcnt vmcnt(29)
    v_mfma_f32_32x32x16_bf16 v[48:63], v[100:103], v[104:107], v[48:63]
    s_waitcnt vmcnt(28)
    v_mfma_f32_32x32x16_bf16 v[32:47], v[96:99], v[108:111], v[32:47]
    v_mfma_f32_32x32x16_bf16 v[64:79], v[100:103], v[108:111], v[64:79]
    buffer_load_dwordx4 v[96:99], v2, s[16:19], s32 offen offset:2048
    buffer_load_dwordx4 v[104:107], v2, s[12:15], s30 offen offset:1024
    buffer_load_dwordx4 v[100:103], v2, s[16:19], s32 offen offset:3072
    buffer_load_dwordx4 v[108:111], v2, s[12:15], s31 offen offset:1024
    s_waitcnt vmcnt(30)
    v_mfma_f32_32x32x16_bf16 v[16:31], v[112:115], v[120:123], v[16:31]
    s_waitcnt vmcnt(29)
    v_mfma_f32_32x32x16_bf16 v[48:63], v[116:119], v[120:123], v[48:63]
    s_waitcnt vmcnt(28)
    v_mfma_f32_32x32x16_bf16 v[32:47], v[112:115], v[124:127], v[32:47]
    v_mfma_f32_32x32x16_bf16 v[64:79], v[116:119], v[124:127], v[64:79]
    s_add_u32 s32, s27, 53248
    buffer_load_dwordx4 v[112:115], v2, s[16:19], s32 offen offset:0
    buffer_load_dwordx4 v[120:123], v2, s[12:15], s30 offen offset:2048
    buffer_load_dwordx4 v[116:119], v2, s[16:19], s32 offen offset:1024
    buffer_load_dwordx4 v[124:127], v2, s[12:15], s31 offen offset:2048
    s_waitcnt vmcnt(30)
    v_mfma_f32_32x32x16_bf16 v[16:31], v[128:131], v[136:139], v[16:31]
    s_waitcnt vmcnt(29)
    v_mfma_f32_32x32x16_bf16 v[48:63], v[132:135], v[136:139], v[48:63]
    s_waitcnt vmcnt(28)
    v_mfma_f32_32x32x16_bf16 v[32:47], v[128:131], v[140:143], v[32:47]
    v_mfma_f32_32x32x16_bf16 v[64:79], v[132:135], v[140:143], v[64:79]
    buffer_load_dwordx4 v[128:131], v2, s[16:19], s32 offen offset:2048
    buffer_load_dwordx4 v[136:139], v2, s[12:15], s30 offen offset:3072
    buffer_load_dwordx4 v[132:135], v2, s[16:19], s32 offen offset:3072
    buffer_load_dwordx4 v[140:143], v2, s[12:15], s31 offen offset:3072
    s_waitcnt vmcnt(30)
    v_mfma_f32_32x32x16_bf16 v[16:31], v[144:147], v[152:155], v[16:31]
    s_waitcnt vmcnt(29)
    v_mfma_f32_32x32x16_bf16 v[48:63], v[148:151], v[152:155], v[48:63]
    s_waitcnt vmcnt(28)
    v_mfma_f32_32x32x16_bf16 v[32:47], v[144:147], v[156:159], v[32:47]
    v_mfma_f32_32x32x16_bf16 v[64:79], v[148:151], v[156:159], v[64:79]
    s_cmp_lg_u32 s8, 0
    s_cbranch_scc1 kd_nopoll
    s_lshl_b32 s33, s9, 2
    v_mov_b32 v3, 0
    s_mov_b32 s35, 0
kd_poll:
    s_add_u32 s35, s35, 1
    s_cmp_ge_u32 s35, 200000
    s_cbranch_scc1 kd_polled
    buffer_load_dword v4, v3, s[40:43], s33 offen sc1
    s_waitcnt vmcnt(0)
    v_readfirstlane_b32 s34, v4
    s_cmp_ge_u32 s34, 8
    s_cbranch_scc1 kd_polled
    s_sleep 4
    s_branch kd_poll
kd_polled:
kd_nopoll:
    s_waitcnt vmcnt(26)
    v_mfma_f32_32x32x16_bf16 v[16:31], v[160:163], v[168:171], v[16:31]
    s_waitcnt vmcnt(25)
    v_mfma_f32_32x32x16_bf16 v[48:63], v[164:167], v[168:171], v[48:63]
    s_waitcnt vmcnt(24)
    v_mfma_f32_32x32x16_bf16 v[32:47], v[160:163], v[172:175], v[32:47]
    v_mfma_f32_32x32x16_bf16 v[64:79], v[164:167], v[172:175], v[64:79]
    s_waitcnt vmcnt(22)
    v_mfma_f32_32x32x16_bf16 v[16:31], v[176:179], v[184:187], v[16:31]
    s_waitcnt vmcnt(21)
    v_mfma_f32_32x32x16_bf16 v[48:63], v[180:183], v[184:187], v[48:63]
    s_waitcnt vmcnt(20)
    v_mfma_f32_32x32x16_bf16 v[32:47], v[176:179], v[188:191], v[32:47]
    v_mfma_f32_32x32x16_bf16 v[64:79], v[180:183], v[188:191], v[64:79]
    s_waitcnt vmcnt(18)
    v_mfma_f32_32x32x16_bf16 v[16:31], v[192:195], v[200:203], v[16:31]
    s_waitcnt vmcnt(17)
    v_mfma_f32_32x32x16_bf16 v[48:63], v[196:199], v[200:203], v[48:63]
    s_waitcnt vmcnt(16)
    v_mfma_f32_32x32x16_bf16 v[32:47], v[192:195], v[204:207], v[32:47]
    v_mfma_f32_32x32x16_bf16 v[64:79], v[196:199], v[204:207], v[64:79]
    s_waitcnt vmcnt(14)
    v_mfma_f32_32x32x16_bf16 v[16:31], v[80:83], v[88:91], v[16:31]
    s_waitcnt vmcnt(13)
    v_mfma_f32_32x32x16_bf16 v[48:63], v[84:87], v[88:91], v[48:63]
    s_waitcnt vmcnt(12)
    v_mfma_f32_32x32x16_bf16 v[32:47], v[80:83], v[92:95], v[32:47]
    v_mfma_f32_32x32x16_bf16 v[64:79], v[84:87], v[92:95], v[64:79]
    s_waitcnt vmcnt(10)
    v_mfma_f32_32x32x16_bf16 v[16:31], v[96:99], v[104:107], v[16:31]
    s_waitcnt vmcnt(9)
    v_mfma_f32_32x32x16_bf16 v[48:63], v[100:103], v[104:107], v[48:63]
    s_waitcnt vmcnt(8)
    v_mfma_f32_32x32x16_bf16 v[32:47], v[96:99], v[108:111], v[32:47]
    v_mfma_f32_32x32x16_bf16 v[64:79], v[100:103], v[108:111], v[64:79]
    s_waitcnt vmcnt(6)
    v_mfma_f32_32x32x16_bf16 v[16:31], v[112:115], v[120:123], v[16:31]
    s_waitcnt vmcnt(5)
    v_mfma_f32_32x32x16_bf16 v[48:63], v[116:119], v[120:123], v[48:63]
    s_waitcnt vmcnt(4)
    v_mfma_f32_32x32x16_bf16 v[32:47], v[112:115], v[124:127], v[32:47]
    v_mfma_f32_32x32x16_bf16 v[64:79], v[116:119], v[124:127], v[64:79]
    s_waitcnt vmcnt(2)
    v_mfma_f32_32x32x16_bf16 v[16:31], v[128:131], v[136:139], v[16:31]
    s_waitcnt vmcnt(1)
    v_mfma_f32_32x32x16_bf16 v[48:63], v[132:135], v[136:139], v[48:63]
    s_waitcnt vmcnt(0)
    v_mfma_f32_32x32x16_bf16 v[32:47], v[128:131], v[140:143], v[32:47]
    v_mfma_f32_32x32x16_bf16 v[64:79], v[132:135], v[140:143], v[64:79]
    s_lshl_b32 s28, s8, 14
    v_add_u32 v3, s28, v2
    s_nop 15
    s_nop 7
    ds_write_b128 v3, v[16:19] offset:0
    ds_write_b128 v3, v[20:23] offset:1024
    ds_write_b128 v3, v[24:27] offset:2048
    ds_write_b128 v3, v[28:31] offset:3072
    ds_write_b128 v3, v[32:35] offset:4096
    ds_write_b128 v3, v[36:39] offset:5120
    ds_write_b128 v3, v[40:43] offset:6144
    ds_write_b128 v3, v[44:47] offset:7168
    ds_write_b128 v3, v[48:51] offset:8192
    ds_write_b128 v3, v[52:55] offset:9216
    ds_write_b128 v3, v[56:59] offset:10240
    ds_write_b128 v3, v[60:63] offset:11264
    ds_write_b128 v3, v[64:67] offset:12288
    ds_write_b128 v3, v[68:71] offset:13312
    ds_write_b128 v3, v[72:75] offset:14336
    ds_write_b128 v3, v[76:79] offset:15360
    s_waitcnt vmcnt(0) lgkmcnt(0)
    s_barrier
    s_lshl_b32 s28, s8, 12
    v_add_u32 v3, s28, v2
    ds_read_b128 v[80:83], v3 offset:0
    ds_read_b128 v[84:87], v3 offset:1024
    ds_read_b128 v[88:91], v3 offset:2048
    ds_read_b128 v[92:95], v3 offset:3072
    ds_read_b128 v[96:99], v3 offset:16384
    ds_read_b128 v[100:103], v3 offset:17408
    ds_read_b128 v[104:107], v3 offset:18432
    ds_read_b128 v[108:111], v3 offset:19456
    ds_read_b128 v[112:115], v3 offset:32768
    ds_read_b128 v[116:119], v3 offset:33792
    ds_read_b128 v[120:123], v3 offset:34816
    ds_read_b128 v[124:127], v3 offset:35840
    ds_read_b128 v[128:131], v3 offset:49152
    ds_read_b128 v[132:135], v3 offset:50176
    ds_read_b128 v[136:139], v3 offset:51200
    ds_read_b128 v[140:143], v3 offset:52224
    v_and_b32 v5, 31, v1
    v_lshlrev_b32 v5, 10, v5
    v_lshrrev_b32 v6, 5, v1
    v_lshlrev_b32 v6, 3, v6
    v_add_u32 v5, v5, v6
    s_lshl_b32 s27, s9, 6
    s_and_b32 s28, s8, 1
    s_lshl_b32 s28, s28, 5
    s_add_u32 s27, s27, s28
    s_lshl_b32 s27, s27, 10
    s_lshl_b32 s28, s10, 6
    s_lshr_b32 s29, s8, 1
    s_lshl_b32 s29, s29, 5
    s_add_u32 s28, s28, s29
    s_lshl_b32 s28, s28, 1
    s_add_u32 s27, s27, s28
    buffer_load_dwordx2 v[156:157], v5, s[48:51], s27 offen offset:0
    buffer_load_dwordx2 v[164:165], v5, s[52:55], s27 offen offset:0 sc1
    buffer_load_dwordx2 v[158:159], v5, s[48:51], s27 offen offset:16
    buffer_load_dwordx2 v[166:167], v5, s[52:55], s27 offen offset:16 sc1
    buffer_load_dwordx2 v[160:161], v5, s[48:51], s27 offen offset:32
    buffer_load_dwordx2 v[168:169], v5, s[52:55], s27 offen offset:32 sc1
    buffer_load_dwordx2 v[162:163], v5, s[48:51], s27 offen offset:48
    buffer_load_dwordx2 v[170:171], v5, s[52:55], s27 offen offset:48 sc1
    s_waitcnt lgkmcnt(0)
    v_pk_add_f32 v[80:81], v[80:81], v[96:97]
    v_pk_add_f32 v[82:83], v[82:83], v[98:99]
    v_pk_add_f32 v[84:85], v[84:85], v[100:101]
    v_pk_add_f32 v[86:87], v[86:87], v[102:103]
    v_pk_add_f32 v[88:89], v[88:89], v[104:105]
    v_pk_add_f32 v[90:91], v[90:91], v[106:107]
    v_pk_add_f32 v[92:93], v[92:93], v[108:109]
    v_pk_add_f32 v[94:95], v[94:95], v[110:111]
    v_pk_add_f32 v[80:81], v[80:81], v[112:113]
    v_pk_add_f32 v[82:83], v[82:83], v[114:115]
    v_pk_add_f32 v[84:85], v[84:85], v[116:117]
    v_pk_add_f32 v[86:87], v[86:87], v[118:119]
    v_pk_add_f32 v[88:89], v[88:89], v[120:121]
    v_pk_add_f32 v[90:91], v[90:91], v[122:123]
    v_pk_add_f32 v[92:93], v[92:93], v[124:125]
    v_pk_add_f32 v[94:95], v[94:95], v[126:127]
    v_pk_add_f32 v[80:81], v[80:81], v[128:129]
    v_pk_add_f32 v[82:83], v[82:83], v[130:131]
    v_pk_add_f32 v[84:85], v[84:85], v[132:133]
    v_pk_add_f32 v[86:87], v[86:87], v[134:135]
    v_pk_add_f32 v[88:89], v[88:89], v[136:137]
    v_pk_add_f32 v[90:91], v[90:91], v[138:139]
    v_pk_add_f32 v[92:93], v[92:93], v[140:141]
    v_pk_add_f32 v[94:95], v[94:95], v[142:143]
    v_cvt_pk_bf16_f32 v144, v80, v81
    v_lshlrev_b32 v80, 16, v144
    v_and_b32 v81, 0xffff0000, v144
    v_mul_f32 v144, s44, v80
    v_mul_f32 v145, s44, v81
    v_exp_f32 v144, v144
    v_exp_f32 v145, v145
    s_nop 0
    v_add_f32 v144, 1.0, v144
    v_add_f32 v145, 1.0, v145
    v_rcp_f32 v144, v144
    v_rcp_f32 v145, v145
    s_nop 0
    v_mul_f32 v80, v80, v144
    v_mul_f32 v81, v81, v145
    v_cvt_pk_bf16_f32 v146, v80, v81
    v_cvt_pk_bf16_f32 v144, v82, v83
    v_lshlrev_b32 v82, 16, v144
    v_and_b32 v83, 0xffff0000, v144
    v_mul_f32 v144, s44, v82
    v_mul_f32 v145, s44, v83
    v_exp_f32 v144, v144
    v_exp_f32 v145, v145
    s_nop 0
    v_add_f32 v144, 1.0, v144
    v_add_f32 v145, 1.0, v145
    v_rcp_f32 v144, v144
    v_rcp_f32 v145, v145
    s_nop 0
    v_mul_f32 v82, v82, v144
    v_mul_f32 v83, v83, v145
    v_cvt_pk_bf16_f32 v147, v82, v83
    v_cvt_pk_bf16_f32 v144, v84, v85
    v_lshlrev_b32 v84, 16, v144
    v_and_b32 v85, 0xffff0000, v144
    v_mul_f32 v144, s44, v84
    v_mul_f32 v145, s44, v85
    v_exp_f32 v144, v144
    v_exp_f32 v145, v145
    s_nop 0
    v_add_f32 v144, 1.0, v144
    v_add_f32 v145, 1.0, v145
    v_rcp_f32 v144, v144
    v_rcp_f32 v145, v145
    s_nop 0
    v_mul_f32 v84, v84, v144
    v_mul_f32 v85, v85, v145
    v_cvt_pk_bf16_f32 v148, v84, v85
    v_cvt_pk_bf16_f32 v144, v86, v87
    v_lshlrev_b32 v86, 16, v144
    v_and_b32 v87, 0xffff0000, v144
    v_mul_f32 v144, s44, v86
    v_mul_f32 v145, s44, v87
    v_exp_f32 v144, v144
    v_exp_f32 v145, v145
    s_nop 0
    v_add_f32 v144, 1.0, v144
    v_add_f32 v145, 1.0, v145
    v_rcp_f32 v144, v144
    v_rcp_f32 v145, v145
    s_nop 0
    v_mul_f32 v86, v86, v144
    v_mul_f32 v87, v87, v145
    v_cvt_pk_bf16_f32 v149, v86, v87
    v_cvt_pk_bf16_f32 v144, v88, v89
    v_lshlrev_b32 v88, 16, v144
    v_and_b32 v89, 0xffff0000, v144
    v_mul_f32 v144, s44, v88
    v_mul_f32 v145, s44, v89
    v_exp_f32 v144, v144
    v_exp_f32 v145, v145
    s_nop 0
    v_add_f32 v144, 1.0, v144
    v_add_f32 v145, 1.0, v145
    v_rcp_f32 v144, v144
    v_rcp_f32 v145, v145
    s_nop 0
    v_mul_f32 v88, v88, v144
    v_mul_f32 v89, v89, v145
    v_cvt_pk_bf16_f32 v150, v88, v89
    v_cvt_pk_bf16_f32 v144, v90, v91
    v_lshlrev_b32 v90, 16, v144
    v_and_b32 v91, 0xffff0000, v144
    v_mul_f32 v144, s44, v90
    v_mul_f32 v145, s44, v91
    v_exp_f32 v144, v144
    v_exp_f32 v145, v145
    s_nop 0
    v_add_f32 v144, 1.0, v144
    v_add_f32 v145, 1.0, v145
    v_rcp_f32 v144, v144
    v_rcp_f32 v145, v145
    s_nop 0
    v_mul_f32 v90, v90, v144
    v_mul_f32 v91, v91, v145
    v_cvt_pk_bf16_f32 v151, v90, v91
    v_cvt_pk_bf16_f32 v144, v92, v93
    v_lshlrev_b32 v92, 16, v144
    v_and_b32 v93, 0xffff0000, v144
    v_mul_f32 v144, s44, v92
    v_mul_f32 v145, s44, v93
    v_exp_f32 v144, v144
    v_exp_f32 v145, v145
    s_nop 0
    v_add_f32 v144, 1.0, v144
    v_add_f32 v145, 1.0, v145
    v_rcp_f32 v144, v144
    v_rcp_f32 v145, v145
    s_nop 0
    v_mul_f32 v92, v92, v144
    v_mul_f32 v93, v93, v145
    v_cvt_pk_bf16_f32 v152, v92, v93
    v_cvt_pk_bf16_f32 v144, v94, v95
    v_lshlrev_b32 v94, 16, v144
    v_and_b32 v95, 0xffff0000, v144
    v_mul_f32 v144, s44, v94
    v_mul_f32 v145, s44, v95
    v_exp_f32 v144, v144
    v_exp_f32 v145, v145
    s_nop 0
    v_add_f32 v144, 1.0, v144
    v_add_f32 v145, 1.0, v145
    v_rcp_f32 v144, v144
    v_rcp_f32 v145, v145
    s_nop 0
    v_mul_f32 v94, v94, v144
    v_mul_f32 v95, v95, v145
    v_cvt_pk_bf16_f32 v153, v94, v95
    s_waitcnt vmcnt(0)
    v_lshlrev_b32 v6, 16, v146
    v_and_b32 v7, 0xffff0000, v146
    v_lshlrev_b32 v8, 16, v164
    v_and_b32 v9, 0xffff0000, v164
    v_mul_f32 v6, v6, v8
    v_mul_f32 v7, v7, v9
    v_cvt_pk_bf16_f32 v6, v6, v7
    v_lshlrev_b32 v8, 16, v156
    v_and_b32 v9, 0xffff0000, v156
    v_and_b32 v7, 0xffff0000, v6
    v_lshlrev_b32 v6, 16, v6
    v_add_f32 v6, v6, v8
    v_add_f32 v7, v7, v9
    v_cvt_pk_bf16_f32 v146, v6, v7
    v_lshlrev_b32 v6, 16, v147
    v_and_b32 v7, 0xffff0000, v147
    v_lshlrev_b32 v8, 16, v165
    v_and_b32 v9, 0xffff0000, v165
    v_mul_f32 v6, v6, v8
    v_mul_f32 v7, v7, v9
    v_cvt_pk_bf16_f32 v6, v6, v7
    v_lshlrev_b32 v8, 16, v157
    v_and_b32 v9, 0xffff0000, v157
    v_and_b32 v7, 0xffff0000, v6
    v_lshlrev_b32 v6, 16, v6
    v_add_f32 v6, v6, v8
    v_add_f32 v7, v7, v9
    v_cvt_pk_bf16_f32 v147, v6, v7
    buffer_store_dwordx2 v[146:147], v5, s[20:23], s27 offen offset:0
    v_lshlrev_b32 v6, 16, v148
    v_and_b32 v7, 0xffff0000, v148
    v_lshlrev_b32 v8, 16, v166
    v_and_b32 v9, 0xffff0000, v166
    v_mul_f32 v6, v6, v8
    v_mul_f32 v7, v7, v9
    v_cvt_pk_bf16_f32 v6, v6, v7
    v_lshlrev_b32 v8, 16, v158
    v_and_b32 v9, 0xffff0000, v158
    v_and_b32 v7, 0xffff0000, v6
    v_lshlrev_b32 v6, 16, v6
    v_add_f32 v6, v6, v8
    v_add_f32 v7, v7, v9
    v_cvt_pk_bf16_f32 v148, v6, v7
    v_lshlrev_b32 v6, 16, v149
    v_and_b32 v7, 0xffff0000, v149
    v_lshlrev_b32 v8, 16, v167
    v_and_b32 v9, 0xffff0000, v167
    v_mul_f32 v6, v6, v8
    v_mul_f32 v7, v7, v9
    v_cvt_pk_bf16_f32 v6, v6, v7
    v_lshlrev_b32 v8, 16, v159
    v_and_b32 v9, 0xffff0000, v159
    v_and_b32 v7, 0xffff0000, v6
    v_lshlrev_b32 v6, 16, v6
    v_add_f32 v6, v6, v8
    v_add_f32 v7, v7, v9
    v_cvt_pk_bf16_f32 v149, v6, v7
    buffer_store_dwordx2 v[148:149], v5, s[20:23], s27 offen offset:16
    v_lshlrev_b32 v6, 16, v150
    v_and_b32 v7, 0xffff0000, v150
    v_lshlrev_b32 v8, 16, v168
    v_and_b32 v9, 0xffff0000, v168
    v_mul_f32 v6, v6, v8
    v_mul_f32 v7, v7, v9
    v_cvt_pk_bf16_f32 v6, v6, v7
    v_lshlrev_b32 v8, 16, v160
    v_and_b32 v9, 0xffff0000, v160
    v_and_b32 v7, 0xffff0000, v6
    v_lshlrev_b32 v6, 16, v6
    v_add_f32 v6, v6, v8
    v_add_f32 v7, v7, v9
    v_cvt_pk_bf16_f32 v150, v6, v7
    v_lshlrev_b32 v6, 16, v151
    v_and_b32 v7, 0xffff0000, v151
    v_lshlrev_b32 v8, 16, v169
    v_and_b32 v9, 0xffff0000, v169
    v_mul_f32 v6, v6, v8
    v_mul_f32 v7, v7, v9
    v_cvt_pk_bf16_f32 v6, v6, v7
    v_lshlrev_b32 v8, 16, v161
    v_and_b32 v9, 0xffff0000, v161
    v_and_b32 v7, 0xffff0000, v6
    v_lshlrev_b32 v6, 16, v6
    v_add_f32 v6, v6, v8
    v_add_f32 v7, v7, v9
    v_cvt_pk_bf16_f32 v151, v6, v7
    buffer_store_dwordx2 v[150:151], v5, s[20:23], s27 offen offset:32
    v_lshlrev_b32 v6, 16, v152
    v_and_b32 v7, 0xffff0000, v152
    v_lshlrev_b32 v8, 16, v170
    v_and_b32 v9, 0xffff0000, v170
    v_mul_f32 v6, v6, v8
    v_mul_f32 v7, v7, v9
    v_cvt_pk_bf16_f32 v6, v6, v7
    v_lshlrev_b32 v8, 16, v162
    v_and_b32 v9, 0xffff0000, v162
    v_and_b32 v7, 0xffff0000, v6
    v_lshlrev_b32 v6, 16, v6
    v_add_f32 v6, v6, v8
    v_add_f32 v7, v7, v9
    v_cvt_pk_bf16_f32 v152, v6, v7
    v_lshlrev_b32 v6, 16, v153
    v_and_b32 v7, 0xffff0000, v153
    v_lshlrev_b32 v8, 16, v171
    v_and_b32 v9, 0xffff0000, v171
    v_mul_f32 v6, v6, v8
    v_mul_f32 v7, v7, v9
    v_cvt_pk_bf16_f32 v6, v6, v7
    v_lshlrev_b32 v8, 16, v163
    v_and_b32 v9, 0xffff0000, v163
    v_and_b32 v7, 0xffff0000, v6
    v_lshlrev_b32 v6, 16, v6
    v_add_f32 v6, v6, v8
    v_add_f32 v7, v7, v9
    v_cvt_pk_bf16_f32 v153, v6, v7
    buffer_store_dwordx2 v[152:153], v5, s[20:23], s27 offen offset:48
    s_endpgm
l3_end:
s_endpgm
.section .rodata,"a"
.p2align 6
.amdhsa_kernel l3_kernel
  .amdhsa_next_free_vgpr 208
  .amdhsa_next_free_sgpr 102
  .amdhsa_accum_offset 208
  .amdhsa_group_segment_fixed_size 0
  .amdhsa_kernarg_size 80
  .amdhsa_user_sgpr_count 2
  .amdhsa_user_sgpr_kernarg_segment_ptr 1
  .amdhsa_system_sgpr_workgroup_id_x 1
.end_amdhsa_kernel
```
